```python
import torch

def _softmax(x, axis=-1):
    return torch.softmax(x, dim=axis)
def _gelu(x):
    return torch.nn.functional.gelu(x, approximate="tanh")
def _silu(x):
    return torch.nn.functional.silu(x)
def _sigmoid(x):
    return torch.sigmoid(x)
def _layernorm(x, axis=-1, eps=1e-5):
    m = x.mean(dim=axis, keepdim=True)
    v = x.var(dim=axis, keepdim=True, unbiased=False)
    return (x - m) / torch.sqrt(v + eps)
def _scatter_add(tgt, idx, src, axis=0):
    return tgt.clone().index_add_(axis, idx, src)
def _segment_sum(src, seg, n):
    out = torch.zeros((n,) + src.shape[1:], dtype=src.dtype)
    return out.index_add_(0, seg, src)
def _pad(x, pw):
    flat = tuple(v for pair in reversed(pw) for v in pair)
    return torch.nn.functional.pad(x, flat)

kernel_name = 'gated_mix__softmax_full_mha__linear_kernel_hedgehog__prompt'

def setup_inputs():

    _w = (lambda a: (lambda t: t.to(torch.bfloat16) if t.is_floating_point() else t)(torch.as_tensor(a)))
    def _A_setup():
        B, S, D = 1, 2048, 640
        return {
            "x": _w((lambda *s: torch.randn(*s, dtype=torch.bfloat16) * 0.05)(B, S, D)),
            "wqkv": _w((lambda *s: torch.randn(*s, dtype=torch.bfloat16) * 0.8)(D, 3 * D)),
            "wo": _w((lambda *s: torch.randn(*s, dtype=torch.bfloat16) * 0.05)(D, D)),
        }
    _A_in = _A_setup()

    def _B_setup():
        B, S, D, H = 1, 2048, 640, 32
        Dh = D // H
        return {
            "x": _w((lambda *s: torch.randn(*s, dtype=torch.bfloat16) * 0.05)(B, S, D)),
            "wqkv": _w((lambda *s: torch.randn(*s, dtype=torch.bfloat16) * 1.6)(D, 3 * D)),
            "w_phi": _w((lambda *s: torch.randn(*s, dtype=torch.bfloat16) * 1.6)(H, Dh, Dh) * (Dh ** -0.5)),
            "wo": _w((lambda *s: torch.randn(*s, dtype=torch.bfloat16) * 0.05)(D, D)),
        }
    _B_in = _B_setup()

    return {
        "A_x": _A_in["x"],
        "A_wqkv": _A_in["wqkv"],
        "A_wo": _A_in["wo"],
        "B_x": _B_in["x"],
        "B_wqkv": _B_in["wqkv"],
        "B_w_phi": _B_in["w_phi"],
        "B_wo": _B_in["wo"],
        "gate_w": _w((lambda *s: torch.randn(*s, dtype=torch.bfloat16) * 0.05)(640) * 16.0),
    }

def reference(A_x, A_wqkv, A_wo, B_x, B_wqkv, B_w_phi, B_wo, gate_w):
    def _A_ref(x, wqkv, wo):
        B, S, D = x.shape
        H = 32; Dh = D // H
        qkv = (lambda x, *d: x.permute(*d))((x @ wqkv).reshape(B, S, 3, H, Dh), 2, 0, 3, 1, 4)
        q, k, v = qkv[0], qkv[1], qkv[2]
        scale = Dh ** -0.5
        scores = torch.einsum("bhqd,bhkd->bhqk", q, k) * scale
        p = _softmax(scores, axis=-1)
        o = torch.einsum("bhqk,bhkd->bhqd", p, v)
        return (lambda x, *d: x.permute(*d))(o, 0, 2, 1, 3).reshape(B, S, D) @ wo

    def _B_ref(x, wqkv, w_phi, wo):
        B, S, D = x.shape
        H = 32; Dh = D // H
        qkv = (lambda x, *d: x.permute(*d))((x @ wqkv).reshape(B, S, 3, H, Dh), 2, 0, 3, 1, 4)
        q, k, v = qkv[0], qkv[1], qkv[2]
        pq = torch.einsum("bhsd,hdf->bhsf", q, w_phi)
        pk = torch.einsum("bhsd,hdf->bhsf", k, w_phi)
        phi_q = torch.concatenate([_softmax(pq, axis=-1), _softmax(-pq, axis=-1)], axis=-1)
        phi_k = torch.concatenate([_softmax(pk, axis=-1), _softmax(-pk, axis=-1)], axis=-1)
        kv = torch.einsum("bhsf,bhsd->bhfd", phi_k, v)
        z  = torch.einsum("bhsf->bhf", phi_k)
        num = torch.einsum("bhqf,bhfd->bhqd", phi_q, kv)
        den = torch.einsum("bhqf,bhf->bhq", phi_q, z)[..., None] + 1e-6
        o = num / den
        return (lambda x, *d: x.permute(*d))(o, 0, 2, 1, 3).reshape(B, S, D) @ wo

    x = A_x
    g = _sigmoid((x * gate_w).sum(-1, keepdims=True))
    a = _A_ref(x, A_wqkv, A_wo)
    b = _B_ref(x, B_wqkv, B_w_phi, B_wo)
    return g * a + (1 - g) * b
```

```asm
; @launch kernel=proj_kernel grid=(256,1,1) block=(768,1,1) lds=163840
; @launch kernel=att_kernel grid=(256,1,1) block=(512,1,1) lds=163840
; @launch kernel=out_kernel grid=(256,1,1) block=(256,1,1) lds=61440
.amdgcn_target "amdgcn-amd-amdhsa--gfx950"
.text
.globl proj_kernel
.p2align 8
.type proj_kernel,@function
proj_kernel:
  s_cmp_ge_u32 s2, 256
  s_cbranch_scc1 L_proj_kernel_exit
  s_load_dwordx4 s[20:23], s[0:1], 0
  s_load_dwordx2 s[26:27], s[0:1], 32
  s_load_dwordx2 s[4:5], s[0:1], 80
  v_and_b32 v1, 63, v0
  v_lshrrev_b32 v2, 6, v0
  s_nop 0
  v_readfirstlane_b32 s8, v2
  s_and_b32 s62, s2, 7
  s_lshr_b32 s63, s2, 3
  s_lshr_b32 s9, s62, 2
  s_bfe_u32 s10, s62, 0x10001
  s_bitcmp1_b32 s62, 0
  s_cbranch_scc1 L_proj_kernel_h1
  s_lshr_b32 s11, s63, 3
  s_and_b32 s12, s63, 7
  s_branch L_proj_kernel_hd
L_proj_kernel_h1:
  s_cmp_ge_u32 s63, 28
  s_cbranch_scc1 L_proj_kernel_aux
  s_mul_i32 s11, s63, 9363
  s_lshr_b32 s11, s11, 16
  s_mul_i32 s12, s11, 7
  s_sub_u32 s12, s63, s12
  s_add_u32 s12, s12, 8
L_proj_kernel_hd:
  s_lshl_b32 s10, s10, 2
  s_add_u32 s11, s11, s10
  s_and_b32 s13, s8, 3
  s_bfe_u32 s14, s8, 0x10002
  s_waitcnt lgkmcnt(0)
  s_mov_b32 s28, s20
  s_mov_b32 s29, s21
  s_mov_b32 s30, 2621440
  s_mov_b32 s31, 0x00020000
  s_cmp_eq_u32 s9, 0
  s_cselect_b32 s32, s22, s26
  s_cselect_b32 s33, s23, s27
  s_mov_b32 s34, 2457600
  s_mov_b32 s35, 0x00020000
  s_mov_b32 s6, 0x10000000
  s_mov_b32 s7, 0x00020000
  s_cmp_lt_u32 s8, 8
  s_cbranch_scc1 L_proj_kernel_compute
  s_sub_u32 s15, s8, 8
  v_lshrrev_b32 v4, 3, v1
  v_lshrrev_b32 v5, 4, v1
  v_and_b32 v6, 7, v1
  s_lshl_b32 s16, s11, 8
  s_lshl_b32 s17, s15, 6
  s_add_u32 s16, s16, s17
  v_add_u32 v4, s16, v4
  s_movk_i32 s17, 1280
  v_mul_lo_u32 v4, v4, s17
  v_add_u32 v7, 0, v5
  v_xor_b32 v7, v6, v7
  v_lshl_add_u32 v16, v7, 4, v4
  v_add_u32 v7, 4, v5
  v_xor_b32 v7, v6, v7
  v_lshl_add_u32 v17, v7, 4, v4
  v_add_u32 v17, 10240, v17
  v_add_u32 v7, 0, v5
  v_xor_b32 v7, v6, v7
  v_lshl_add_u32 v18, v7, 4, v4
  v_add_u32 v18, 20480, v18
  v_add_u32 v7, 4, v5
  v_xor_b32 v7, v6, v7
  v_lshl_add_u32 v19, v7, 4, v4
  v_add_u32 v19, 30720, v19
  v_add_u32 v7, 0, v5
  v_xor_b32 v7, v6, v7
  v_lshl_add_u32 v20, v7, 4, v4
  v_add_u32 v20, 40960, v20
  v_add_u32 v7, 4, v5
  v_xor_b32 v7, v6, v7
  v_lshl_add_u32 v21, v7, 4, v4
  v_add_u32 v21, 51200, v21
  v_add_u32 v7, 0, v5
  v_xor_b32 v7, v6, v7
  v_lshl_add_u32 v22, v7, 4, v4
  v_add_u32 v22, 61440, v22
  v_add_u32 v7, 4, v5
  v_xor_b32 v7, v6, v7
  v_lshl_add_u32 v23, v7, 4, v4
  v_add_u32 v23, 71680, v23
  v_and_b32 v6, 15, v1
  v_lshlrev_b32 v7, 2, v5
  v_xor_b32 v6, v6, v7
  v_lshlrev_b32 v6, 4, v6
  s_lshl_b32 s16, s15, 3
  v_add_u32 v5, s16, v5
  s_movk_i32 s17, 3840
  v_mul_lo_u32 v5, v5, s17
  s_lshl_b32 s16, s12, 8
  v_add3_u32 v24, v5, v6, s16
  v_add_u32 v25, 15360, v24
  v_add_u32 v26, 30720, v24
  v_add_u32 v27, 46080, v24
  s_lshl_b32 s18, s15, 13
  s_lshl_b32 s19, s15, 11
  s_add_u32 s19, s19, 131072
  s_mov_b32 s37, 0
  s_add_u32 m0, s19, 0
  s_nop 0
  buffer_load_dwordx4 v24, s[32:35], s37 offen lds
  s_add_u32 m0, s19, 1024
  s_nop 0
  buffer_load_dwordx4 v25, s[32:35], s37 offen lds
  s_movk_i32 s36, 0
  s_add_u32 m0, s18, 0
  s_nop 0
  buffer_load_dwordx4 v16, s[28:31], s36 offen lds
  s_add_u32 m0, s18, 1024
  s_nop 0
  buffer_load_dwordx4 v17, s[28:31], s36 offen lds
  s_add_u32 m0, s18, 2048
  s_nop 0
  buffer_load_dwordx4 v18, s[28:31], s36 offen lds
  s_add_u32 m0, s18, 3072
  s_nop 0
  buffer_load_dwordx4 v19, s[28:31], s36 offen lds
  s_add_u32 m0, s18, 4096
  s_nop 0
  buffer_load_dwordx4 v20, s[28:31], s36 offen lds
  s_add_u32 m0, s18, 5120
  s_nop 0
  buffer_load_dwordx4 v21, s[28:31], s36 offen lds
  s_add_u32 m0, s18, 6144
  s_nop 0
  buffer_load_dwordx4 v22, s[28:31], s36 offen lds
  s_add_u32 m0, s18, 7168
  s_nop 0
  buffer_load_dwordx4 v23, s[28:31], s36 offen lds
  s_mov_b32 s37, 122880
  s_add_u32 m0, s19, 8192
  s_nop 0
  buffer_load_dwordx4 v24, s[32:35], s37 offen lds
  s_add_u32 m0, s19, 9216
  s_nop 0
  buffer_load_dwordx4 v25, s[32:35], s37 offen lds
  s_movk_i32 s36, 128
  s_add_u32 m0, s18, 32768
  s_nop 0
  buffer_load_dwordx4 v16, s[28:31], s36 offen lds
  s_add_u32 m0, s18, 33792
  s_nop 0
  buffer_load_dwordx4 v17, s[28:31], s36 offen lds
  s_add_u32 m0, s18, 34816
  s_nop 0
  buffer_load_dwordx4 v18, s[28:31], s36 offen lds
  s_add_u32 m0, s18, 35840
  s_nop 0
  buffer_load_dwordx4 v19, s[28:31], s36 offen lds
  s_add_u32 m0, s18, 36864
  s_nop 0
  buffer_load_dwordx4 v20, s[28:31], s36 offen lds
  s_add_u32 m0, s18, 37888
  s_nop 0
  buffer_load_dwordx4 v21, s[28:31], s36 offen lds
  s_add_u32 m0, s18, 38912
  s_nop 0
  buffer_load_dwordx4 v22, s[28:31], s36 offen lds
  s_add_u32 m0, s18, 39936
  s_nop 0
  buffer_load_dwordx4 v23, s[28:31], s36 offen lds
  s_mov_b32 s37, 245760
  s_add_u32 m0, s19, 16384
  s_nop 0
  buffer_load_dwordx4 v24, s[32:35], s37 offen lds
  s_add_u32 m0, s19, 17408
  s_nop 0
  buffer_load_dwordx4 v25, s[32:35], s37 offen lds
  s_waitcnt vmcnt(12)
  s_barrier
  s_movk_i32 s36, 256
  s_add_u32 m0, s18, 65536
  s_nop 0
  buffer_load_dwordx4 v16, s[28:31], s36 offen lds
  s_add_u32 m0, s18, 66560
  s_nop 0
  buffer_load_dwordx4 v17, s[28:31], s36 offen lds
  s_add_u32 m0, s18, 67584
  s_nop 0
  buffer_load_dwordx4 v18, s[28:31], s36 offen lds
  s_add_u32 m0, s18, 68608
  s_nop 0
  buffer_load_dwordx4 v19, s[28:31], s36 offen lds
  s_add_u32 m0, s18, 69632
  s_nop 0
  buffer_load_dwordx4 v20, s[28:31], s36 offen lds
  s_add_u32 m0, s18, 70656
  s_nop 0
  buffer_load_dwordx4 v21, s[28:31], s36 offen lds
  s_add_u32 m0, s18, 71680
  s_nop 0
  buffer_load_dwordx4 v22, s[28:31], s36 offen lds
  s_add_u32 m0, s18, 72704
  s_nop 0
  buffer_load_dwordx4 v23, s[28:31], s36 offen lds
  s_waitcnt vmcnt(18)
  s_barrier
  s_mov_b32 s37, 368640
  s_add_u32 m0, s19, 24576
  s_nop 0
  buffer_load_dwordx4 v24, s[32:35], s37 offen lds
  s_add_u32 m0, s19, 25600
  s_nop 0
  buffer_load_dwordx4 v25, s[32:35], s37 offen lds
  s_waitcnt vmcnt(10)
  s_barrier
  s_mov_b32 s37, 491520
  s_add_u32 m0, s19, 0
  s_nop 0
  buffer_load_dwordx4 v24, s[32:35], s37 offen lds
  s_add_u32 m0, s19, 1024
  s_nop 0
  buffer_load_dwordx4 v25, s[32:35], s37 offen lds
  s_movk_i32 s36, 384
  s_add_u32 m0, s18, 98304
  s_nop 0
  buffer_load_dwordx4 v16, s[28:31], s36 offen lds
  s_add_u32 m0, s18, 99328
  s_nop 0
  buffer_load_dwordx4 v17, s[28:31], s36 offen lds
  s_add_u32 m0, s18, 100352
  s_nop 0
  buffer_load_dwordx4 v18, s[28:31], s36 offen lds
  s_add_u32 m0, s18, 101376
  s_nop 0
  buffer_load_dwordx4 v19, s[28:31], s36 offen lds
  s_add_u32 m0, s18, 102400
  s_nop 0
  buffer_load_dwordx4 v20, s[28:31], s36 offen lds
  s_add_u32 m0, s18, 103424
  s_nop 0
  buffer_load_dwordx4 v21, s[28:31], s36 offen lds
  s_add_u32 m0, s18, 104448
  s_nop 0
  buffer_load_dwordx4 v22, s[28:31], s36 offen lds
  s_add_u32 m0, s18, 105472
  s_nop 0
  buffer_load_dwordx4 v23, s[28:31], s36 offen lds
  s_waitcnt vmcnt(10)
  s_barrier
  s_mov_b32 s37, 614400
  s_add_u32 m0, s19, 8192
  s_nop 0
  buffer_load_dwordx4 v24, s[32:35], s37 offen lds
  s_add_u32 m0, s19, 9216
  s_nop 0
  buffer_load_dwordx4 v25, s[32:35], s37 offen lds
  s_movk_i32 s36, 512
  s_add_u32 m0, s18, 0
  s_nop 0
  buffer_load_dwordx4 v16, s[28:31], s36 offen lds
  s_add_u32 m0, s18, 1024
  s_nop 0
  buffer_load_dwordx4 v17, s[28:31], s36 offen lds
  s_add_u32 m0, s18, 2048
  s_nop 0
  buffer_load_dwordx4 v18, s[28:31], s36 offen lds
  s_add_u32 m0, s18, 3072
  s_nop 0
  buffer_load_dwordx4 v19, s[28:31], s36 offen lds
  s_add_u32 m0, s18, 4096
  s_nop 0
  buffer_load_dwordx4 v20, s[28:31], s36 offen lds
  s_add_u32 m0, s18, 5120
  s_nop 0
  buffer_load_dwordx4 v21, s[28:31], s36 offen lds
  s_add_u32 m0, s18, 6144
  s_nop 0
  buffer_load_dwordx4 v22, s[28:31], s36 offen lds
  s_add_u32 m0, s18, 7168
  s_nop 0
  buffer_load_dwordx4 v23, s[28:31], s36 offen lds
  s_waitcnt vmcnt(18)
  s_barrier
  s_mov_b32 s37, 737280
  s_add_u32 m0, s19, 16384
  s_nop 0
  buffer_load_dwordx4 v24, s[32:35], s37 offen lds
  s_add_u32 m0, s19, 17408
  s_nop 0
  buffer_load_dwordx4 v25, s[32:35], s37 offen lds
  s_waitcnt vmcnt(10)
  s_barrier
  s_mov_b32 s37, 860160
  s_add_u32 m0, s19, 24576
  s_nop 0
  buffer_load_dwordx4 v24, s[32:35], s37 offen lds
  s_add_u32 m0, s19, 25600
  s_nop 0
  buffer_load_dwordx4 v25, s[32:35], s37 offen lds
  s_movk_i32 s36, 640
  s_add_u32 m0, s18, 32768
  s_nop 0
  buffer_load_dwordx4 v16, s[28:31], s36 offen lds
  s_add_u32 m0, s18, 33792
  s_nop 0
  buffer_load_dwordx4 v17, s[28:31], s36 offen lds
  s_add_u32 m0, s18, 34816
  s_nop 0
  buffer_load_dwordx4 v18, s[28:31], s36 offen lds
  s_add_u32 m0, s18, 35840
  s_nop 0
  buffer_load_dwordx4 v19, s[28:31], s36 offen lds
  s_add_u32 m0, s18, 36864
  s_nop 0
  buffer_load_dwordx4 v20, s[28:31], s36 offen lds
  s_add_u32 m0, s18, 37888
  s_nop 0
  buffer_load_dwordx4 v21, s[28:31], s36 offen lds
  s_add_u32 m0, s18, 38912
  s_nop 0
  buffer_load_dwordx4 v22, s[28:31], s36 offen lds
  s_add_u32 m0, s18, 39936
  s_nop 0
  buffer_load_dwordx4 v23, s[28:31], s36 offen lds
  s_waitcnt vmcnt(10)
  s_barrier
  s_mov_b32 s37, 983040
  s_add_u32 m0, s19, 0
  s_nop 0
  buffer_load_dwordx4 v24, s[32:35], s37 offen lds
  s_add_u32 m0, s19, 1024
  s_nop 0
  buffer_load_dwordx4 v25, s[32:35], s37 offen lds
  s_waitcnt vmcnt(10)
  s_barrier
  s_mov_b32 s37, 1105920
  s_add_u32 m0, s19, 8192
  s_nop 0
  buffer_load_dwordx4 v24, s[32:35], s37 offen lds
  s_add_u32 m0, s19, 9216
  s_nop 0
  buffer_load_dwordx4 v25, s[32:35], s37 offen lds
  s_movk_i32 s36, 768
  s_add_u32 m0, s18, 65536
  s_nop 0
  buffer_load_dwordx4 v16, s[28:31], s36 offen lds
  s_add_u32 m0, s18, 66560
  s_nop 0
  buffer_load_dwordx4 v17, s[28:31], s36 offen lds
  s_add_u32 m0, s18, 67584
  s_nop 0
  buffer_load_dwordx4 v18, s[28:31], s36 offen lds
  s_add_u32 m0, s18, 68608
  s_nop 0
  buffer_load_dwordx4 v19, s[28:31], s36 offen lds
  s_add_u32 m0, s18, 69632
  s_nop 0
  buffer_load_dwordx4 v20, s[28:31], s36 offen lds
  s_add_u32 m0, s18, 70656
  s_nop 0
  buffer_load_dwordx4 v21, s[28:31], s36 offen lds
  s_add_u32 m0, s18, 71680
  s_nop 0
  buffer_load_dwordx4 v22, s[28:31], s36 offen lds
  s_add_u32 m0, s18, 72704
  s_nop 0
  buffer_load_dwordx4 v23, s[28:31], s36 offen lds
  s_waitcnt vmcnt(10)
  s_barrier
  s_mov_b32 s37, 1228800
  s_add_u32 m0, s19, 16384
  s_nop 0
  buffer_load_dwordx4 v24, s[32:35], s37 offen lds
  s_add_u32 m0, s19, 17408
  s_nop 0
  buffer_load_dwordx4 v25, s[32:35], s37 offen lds
  s_waitcnt vmcnt(10)
  s_barrier
  s_mov_b32 s37, 1351680
  s_add_u32 m0, s19, 24576
  s_nop 0
  buffer_load_dwordx4 v24, s[32:35], s37 offen lds
  s_add_u32 m0, s19, 25600
  s_nop 0
  buffer_load_dwordx4 v25, s[32:35], s37 offen lds
  s_movk_i32 s36, 896
  s_add_u32 m0, s18, 98304
  s_nop 0
  buffer_load_dwordx4 v16, s[28:31], s36 offen lds
  s_add_u32 m0, s18, 99328
  s_nop 0
  buffer_load_dwordx4 v17, s[28:31], s36 offen lds
  s_add_u32 m0, s18, 100352
  s_nop 0
  buffer_load_dwordx4 v18, s[28:31], s36 offen lds
  s_add_u32 m0, s18, 101376
  s_nop 0
  buffer_load_dwordx4 v19, s[28:31], s36 offen lds
  s_add_u32 m0, s18, 102400
  s_nop 0
  buffer_load_dwordx4 v20, s[28:31], s36 offen lds
  s_add_u32 m0, s18, 103424
  s_nop 0
  buffer_load_dwordx4 v21, s[28:31], s36 offen lds
  s_add_u32 m0, s18, 104448
  s_nop 0
  buffer_load_dwordx4 v22, s[28:31], s36 offen lds
  s_add_u32 m0, s18, 105472
  s_nop 0
  buffer_load_dwordx4 v23, s[28:31], s36 offen lds
  s_waitcnt vmcnt(10)
  s_barrier
  s_mov_b32 s37, 1474560
  s_add_u32 m0, s19, 0
  s_nop 0
  buffer_load_dwordx4 v24, s[32:35], s37 offen lds
  s_add_u32 m0, s19, 1024
  s_nop 0
  buffer_load_dwordx4 v25, s[32:35], s37 offen lds
  s_waitcnt vmcnt(10)
  s_barrier
  s_mov_b32 s37, 1597440
  s_add_u32 m0, s19, 8192
  s_nop 0
  buffer_load_dwordx4 v24, s[32:35], s37 offen lds
  s_add_u32 m0, s19, 9216
  s_nop 0
  buffer_load_dwordx4 v25, s[32:35], s37 offen lds
  s_movk_i32 s36, 1024
  s_add_u32 m0, s18, 0
  s_nop 0
  buffer_load_dwordx4 v16, s[28:31], s36 offen lds
  s_add_u32 m0, s18, 1024
  s_nop 0
  buffer_load_dwordx4 v17, s[28:31], s36 offen lds
  s_add_u32 m0, s18, 2048
  s_nop 0
  buffer_load_dwordx4 v18, s[28:31], s36 offen lds
  s_add_u32 m0, s18, 3072
  s_nop 0
  buffer_load_dwordx4 v19, s[28:31], s36 offen lds
  s_add_u32 m0, s18, 4096
  s_nop 0
  buffer_load_dwordx4 v20, s[28:31], s36 offen lds
  s_add_u32 m0, s18, 5120
  s_nop 0
  buffer_load_dwordx4 v21, s[28:31], s36 offen lds
  s_add_u32 m0, s18, 6144
  s_nop 0
  buffer_load_dwordx4 v22, s[28:31], s36 offen lds
  s_add_u32 m0, s18, 7168
  s_nop 0
  buffer_load_dwordx4 v23, s[28:31], s36 offen lds
  s_waitcnt vmcnt(10)
  s_barrier
  s_mov_b32 s37, 1720320
  s_add_u32 m0, s19, 16384
  s_nop 0
  buffer_load_dwordx4 v24, s[32:35], s37 offen lds
  s_add_u32 m0, s19, 17408
  s_nop 0
  buffer_load_dwordx4 v25, s[32:35], s37 offen lds
  s_waitcnt vmcnt(10)
  s_barrier
  s_mov_b32 s37, 1843200
  s_add_u32 m0, s19, 24576
  s_nop 0
  buffer_load_dwordx4 v24, s[32:35], s37 offen lds
  s_add_u32 m0, s19, 25600
  s_nop 0
  buffer_load_dwordx4 v25, s[32:35], s37 offen lds
  s_movk_i32 s36, 1152
  s_add_u32 m0, s18, 32768
  s_nop 0
  buffer_load_dwordx4 v16, s[28:31], s36 offen lds
  s_add_u32 m0, s18, 33792
  s_nop 0
  buffer_load_dwordx4 v17, s[28:31], s36 offen lds
  s_add_u32 m0, s18, 34816
  s_nop 0
  buffer_load_dwordx4 v18, s[28:31], s36 offen lds
  s_add_u32 m0, s18, 35840
  s_nop 0
  buffer_load_dwordx4 v19, s[28:31], s36 offen lds
  s_add_u32 m0, s18, 36864
  s_nop 0
  buffer_load_dwordx4 v20, s[28:31], s36 offen lds
  s_add_u32 m0, s18, 37888
  s_nop 0
  buffer_load_dwordx4 v21, s[28:31], s36 offen lds
  s_add_u32 m0, s18, 38912
  s_nop 0
  buffer_load_dwordx4 v22, s[28:31], s36 offen lds
  s_add_u32 m0, s18, 39936
  s_nop 0
  buffer_load_dwordx4 v23, s[28:31], s36 offen lds
  s_waitcnt vmcnt(10)
  s_barrier
  s_mov_b32 s37, 1966080
  s_add_u32 m0, s19, 0
  s_nop 0
  buffer_load_dwordx4 v24, s[32:35], s37 offen lds
  s_add_u32 m0, s19, 1024
  s_nop 0
  buffer_load_dwordx4 v25, s[32:35], s37 offen lds
  s_waitcnt vmcnt(10)
  s_barrier
  s_mov_b32 s37, 2088960
  s_add_u32 m0, s19, 8192
  s_nop 0
  buffer_load_dwordx4 v24, s[32:35], s37 offen lds
  s_add_u32 m0, s19, 9216
  s_nop 0
  buffer_load_dwordx4 v25, s[32:35], s37 offen lds
  s_waitcnt vmcnt(2)
  s_barrier
  s_mov_b32 s37, 2211840
  s_add_u32 m0, s19, 16384
  s_nop 0
  buffer_load_dwordx4 v24, s[32:35], s37 offen lds
  s_add_u32 m0, s19, 17408
  s_nop 0
  buffer_load_dwordx4 v25, s[32:35], s37 offen lds
  s_waitcnt vmcnt(2)
  s_barrier
  s_mov_b32 s37, 2334720
  s_add_u32 m0, s19, 24576
  s_nop 0
  buffer_load_dwordx4 v24, s[32:35], s37 offen lds
  s_add_u32 m0, s19, 25600
  s_nop 0
  buffer_load_dwordx4 v25, s[32:35], s37 offen lds
  s_waitcnt vmcnt(2)
  s_barrier
  s_waitcnt vmcnt(0)
  s_barrier
  s_branch L_proj_kernel_exit
L_proj_kernel_compute:
  v_and_b32 v4, 31, v1
  v_lshrrev_b32 v5, 5, v1
  v_bfe_u32 v6, v1, 1, 3
  v_xor_b32 v6, v6, v5
  v_lshlrev_b32 v7, 7, v4
  s_lshl_b32 s16, s13, 13
  v_add_u32 v7, s16, v7
  v_lshl_add_u32 v7, v6, 4, v7
  v_xor_b32 v128, 0, v7
  v_xor_b32 v129, 32, v7
  v_xor_b32 v130, 64, v7
  v_xor_b32 v131, 96, v7
  v_bfe_u32 v4, v1, 4, 1
  v_bfe_u32 v6, v1, 2, 2
  v_and_b32 v7, 3, v1
  v_lshlrev_b32 v8, 3, v5
  v_add_u32 v8, v8, v6
  v_lshlrev_b32 v8, 8, v8
  v_add_u32 v8, 131072, v8
  v_lshlrev_b32 v9, 1, v4
  v_lshrrev_b32 v10, 1, v7
  v_add_u32 v9, v9, v10
  v_lshl_add_u32 v8, v9, 4, v8
  v_and_b32 v10, 1, v7
  v_lshl_add_u32 v8, v10, 3, v8
  v_lshlrev_b32 v6, 2, v6
  s_lshl_b32 s16, s14, 3
  s_add_u32 s17, s16, 0
  v_xor_b32 v9, s17, v6
  v_lshl_add_u32 v54, v9, 4, v8
  s_add_u32 s17, s16, 4
  v_xor_b32 v9, s17, v6
  v_lshl_add_u32 v55, v9, 4, v8
  v_add_u32 v132, 32768, v128
  v_add_u32 v133, 32768, v129
  v_add_u32 v134, 32768, v130
  v_add_u32 v135, 32768, v131
  v_add_u32 v136, 65536, v128
  v_add_u32 v137, 65536, v129
  v_add_u32 v138, 65536, v130
  v_add_u32 v139, 65536, v131
  v_add_u32 v140, 98304, v128
  v_add_u32 v141, 98304, v129
  v_add_u32 v142, 98304, v130
  v_add_u32 v143, 98304, v131
  v_mov_b32 v64, 0
  v_mov_b32 v65, 0
  v_mov_b32 v66, 0
  v_mov_b32 v67, 0
  v_mov_b32 v68, 0
  v_mov_b32 v69, 0
  v_mov_b32 v70, 0
  v_mov_b32 v71, 0
  v_mov_b32 v72, 0
  v_mov_b32 v73, 0
  v_mov_b32 v74, 0
  v_mov_b32 v75, 0
  v_mov_b32 v76, 0
  v_mov_b32 v77, 0
  v_mov_b32 v78, 0
  v_mov_b32 v79, 0
  v_mov_b32 v80, 0
  v_mov_b32 v81, 0
  v_mov_b32 v82, 0
  v_mov_b32 v83, 0
  v_mov_b32 v84, 0
  v_mov_b32 v85, 0
  v_mov_b32 v86, 0
  v_mov_b32 v87, 0
  v_mov_b32 v88, 0
  v_mov_b32 v89, 0
  v_mov_b32 v90, 0
  v_mov_b32 v91, 0
  v_mov_b32 v92, 0
  v_mov_b32 v93, 0
  v_mov_b32 v94, 0
  v_mov_b32 v95, 0
  v_mov_b32 v96, 0
  v_mov_b32 v97, 0
  v_mov_b32 v98, 0
  v_mov_b32 v99, 0
  v_mov_b32 v100, 0
  v_mov_b32 v101, 0
  v_mov_b32 v102, 0
  v_mov_b32 v103, 0
  v_mov_b32 v104, 0
  v_mov_b32 v105, 0
  v_mov_b32 v106, 0
  v_mov_b32 v107, 0
  v_mov_b32 v108, 0
  v_mov_b32 v109, 0
  v_mov_b32 v110, 0
  v_mov_b32 v111, 0
  v_mov_b32 v112, 0
  v_mov_b32 v113, 0
  v_mov_b32 v114, 0
  v_mov_b32 v115, 0
  v_mov_b32 v116, 0
  v_mov_b32 v117, 0
  v_mov_b32 v118, 0
  v_mov_b32 v119, 0
  v_mov_b32 v120, 0
  v_mov_b32 v121, 0
  v_mov_b32 v122, 0
  v_mov_b32 v123, 0
  v_mov_b32 v124, 0
  v_mov_b32 v125, 0
  v_mov_b32 v126, 0
  v_mov_b32 v127, 0
  s_cmp_ge_u32 s12, 10
  s_cbranch_scc1 L_proj_kernel_v
  s_barrier
  ds_read_b128 v[16:19], v128 offset:0
  ds_read_b128 v[20:23], v128 offset:4096
  ds_read_b64_tr_b16 v[32:33], v54 offset:0
  ds_read_b64_tr_b16 v[34:35], v54 offset:1024
  ds_read_b64_tr_b16 v[36:37], v55 offset:0
  ds_read_b64_tr_b16 v[38:39], v55 offset:1024
  ds_read_b128 v[24:27], v129 offset:0
  ds_read_b128 v[28:31], v129 offset:4096
  ds_read_b64_tr_b16 v[40:41], v54 offset:4096
  ds_read_b64_tr_b16 v[42:43], v54 offset:5120
  ds_read_b64_tr_b16 v[44:45], v55 offset:4096
  ds_read_b64_tr_b16 v[46:47], v55 offset:5120
  s_waitcnt lgkmcnt(6)
  v_mfma_f32_32x32x16_bf16 v[64:79], v[32:35], v[16:19], v[64:79]
  v_mfma_f32_32x32x16_bf16 v[80:95], v[32:35], v[20:23], v[80:95]
  v_mfma_f32_32x32x16_bf16 v[96:111], v[36:39], v[16:19], v[96:111]
  v_mfma_f32_32x32x16_bf16 v[112:127], v[36:39], v[20:23], v[112:127]
  s_barrier
  ds_read_b128 v[16:19], v130 offset:0
  ds_read_b128 v[20:23], v130 offset:4096
  ds_read_b64_tr_b16 v[32:33], v54 offset:8192
  ds_read_b64_tr_b16 v[34:35], v54 offset:9216
  ds_read_b64_tr_b16 v[36:37], v55 offset:8192
  ds_read_b64_tr_b16 v[38:39], v55 offset:9216
  s_waitcnt lgkmcnt(6)
  v_mfma_f32_32x32x16_bf16 v[64:79], v[40:43], v[24:27], v[64:79]
  v_mfma_f32_32x32x16_bf16 v[80:95], v[40:43], v[28:31], v[80:95]
  v_mfma_f32_32x32x16_bf16 v[96:111], v[44:47], v[24:27], v[96:111]
  v_mfma_f32_32x32x16_bf16 v[112:127], v[44:47], v[28:31], v[112:127]
  ds_read_b128 v[24:27], v131 offset:0
  ds_read_b128 v[28:31], v131 offset:4096
  ds_read_b64_tr_b16 v[40:41], v54 offset:12288
  ds_read_b64_tr_b16 v[42:43], v54 offset:13312
  ds_read_b64_tr_b16 v[44:45], v55 offset:12288
  ds_read_b64_tr_b16 v[46:47], v55 offset:13312
  s_waitcnt lgkmcnt(6)
  v_mfma_f32_32x32x16_bf16 v[64:79], v[32:35], v[16:19], v[64:79]
  v_mfma_f32_32x32x16_bf16 v[80:95], v[32:35], v[20:23], v[80:95]
  v_mfma_f32_32x32x16_bf16 v[96:111], v[36:39], v[16:19], v[96:111]
  v_mfma_f32_32x32x16_bf16 v[112:127], v[36:39], v[20:23], v[112:127]
  s_barrier
  ds_read_b128 v[16:19], v132 offset:0
  ds_read_b128 v[20:23], v132 offset:4096
  ds_read_b64_tr_b16 v[32:33], v54 offset:16384
  ds_read_b64_tr_b16 v[34:35], v54 offset:17408
  ds_read_b64_tr_b16 v[36:37], v55 offset:16384
  ds_read_b64_tr_b16 v[38:39], v55 offset:17408
  s_waitcnt lgkmcnt(6)
  v_mfma_f32_32x32x16_bf16 v[64:79], v[40:43], v[24:27], v[64:79]
  v_mfma_f32_32x32x16_bf16 v[80:95], v[40:43], v[28:31], v[80:95]
  v_mfma_f32_32x32x16_bf16 v[96:111], v[44:47], v[24:27], v[96:111]
  v_mfma_f32_32x32x16_bf16 v[112:127], v[44:47], v[28:31], v[112:127]
  ds_read_b128 v[24:27], v133 offset:0
  ds_read_b128 v[28:31], v133 offset:4096
  ds_read_b64_tr_b16 v[40:41], v54 offset:20480
  ds_read_b64_tr_b16 v[42:43], v54 offset:21504
  ds_read_b64_tr_b16 v[44:45], v55 offset:20480
  ds_read_b64_tr_b16 v[46:47], v55 offset:21504
  s_waitcnt lgkmcnt(6)
  v_mfma_f32_32x32x16_bf16 v[64:79], v[32:35], v[16:19], v[64:79]
  v_mfma_f32_32x32x16_bf16 v[80:95], v[32:35], v[20:23], v[80:95]
  v_mfma_f32_32x32x16_bf16 v[96:111], v[36:39], v[16:19], v[96:111]
  v_mfma_f32_32x32x16_bf16 v[112:127], v[36:39], v[20:23], v[112:127]
  s_barrier
  ds_read_b128 v[16:19], v134 offset:0
  ds_read_b128 v[20:23], v134 offset:4096
  ds_read_b64_tr_b16 v[32:33], v54 offset:24576
  ds_read_b64_tr_b16 v[34:35], v54 offset:25600
  ds_read_b64_tr_b16 v[36:37], v55 offset:24576
  ds_read_b64_tr_b16 v[38:39], v55 offset:25600
  s_waitcnt lgkmcnt(6)
  v_mfma_f32_32x32x16_bf16 v[64:79], v[40:43], v[24:27], v[64:79]
  v_mfma_f32_32x32x16_bf16 v[80:95], v[40:43], v[28:31], v[80:95]
  v_mfma_f32_32x32x16_bf16 v[96:111], v[44:47], v[24:27], v[96:111]
  v_mfma_f32_32x32x16_bf16 v[112:127], v[44:47], v[28:31], v[112:127]
  ds_read_b128 v[24:27], v135 offset:0
  ds_read_b128 v[28:31], v135 offset:4096
  ds_read_b64_tr_b16 v[40:41], v54 offset:28672
  ds_read_b64_tr_b16 v[42:43], v54 offset:29696
  ds_read_b64_tr_b16 v[44:45], v55 offset:28672
  ds_read_b64_tr_b16 v[46:47], v55 offset:29696
  s_waitcnt lgkmcnt(6)
  v_mfma_f32_32x32x16_bf16 v[64:79], v[32:35], v[16:19], v[64:79]
  v_mfma_f32_32x32x16_bf16 v[80:95], v[32:35], v[20:23], v[80:95]
  v_mfma_f32_32x32x16_bf16 v[96:111], v[36:39], v[16:19], v[96:111]
  v_mfma_f32_32x32x16_bf16 v[112:127], v[36:39], v[20:23], v[112:127]
  s_barrier
  ds_read_b128 v[16:19], v136 offset:0
  ds_read_b128 v[20:23], v136 offset:4096
  ds_read_b64_tr_b16 v[32:33], v54 offset:0
  ds_read_b64_tr_b16 v[34:35], v54 offset:1024
  ds_read_b64_tr_b16 v[36:37], v55 offset:0
  ds_read_b64_tr_b16 v[38:39], v55 offset:1024
  s_waitcnt lgkmcnt(6)
  v_mfma_f32_32x32x16_bf16 v[64:79], v[40:43], v[24:27], v[64:79]
  v_mfma_f32_32x32x16_bf16 v[80:95], v[40:43], v[28:31], v[80:95]
  v_mfma_f32_32x32x16_bf16 v[96:111], v[44:47], v[24:27], v[96:111]
  v_mfma_f32_32x32x16_bf16 v[112:127], v[44:47], v[28:31], v[112:127]
  ds_read_b128 v[24:27], v137 offset:0
  ds_read_b128 v[28:31], v137 offset:4096
  ds_read_b64_tr_b16 v[40:41], v54 offset:4096
  ds_read_b64_tr_b16 v[42:43], v54 offset:5120
  ds_read_b64_tr_b16 v[44:45], v55 offset:4096
  ds_read_b64_tr_b16 v[46:47], v55 offset:5120
  s_waitcnt lgkmcnt(6)
  v_mfma_f32_32x32x16_bf16 v[64:79], v[32:35], v[16:19], v[64:79]
  v_mfma_f32_32x32x16_bf16 v[80:95], v[32:35], v[20:23], v[80:95]
  v_mfma_f32_32x32x16_bf16 v[96:111], v[36:39], v[16:19], v[96:111]
  v_mfma_f32_32x32x16_bf16 v[112:127], v[36:39], v[20:23], v[112:127]
  s_barrier
  ds_read_b128 v[16:19], v138 offset:0
  ds_read_b128 v[20:23], v138 offset:4096
  ds_read_b64_tr_b16 v[32:33], v54 offset:8192
  ds_read_b64_tr_b16 v[34:35], v54 offset:9216
  ds_read_b64_tr_b16 v[36:37], v55 offset:8192
  ds_read_b64_tr_b16 v[38:39], v55 offset:9216
  s_waitcnt lgkmcnt(6)
  v_mfma_f32_32x32x16_bf16 v[64:79], v[40:43], v[24:27], v[64:79]
  v_mfma_f32_32x32x16_bf16 v[80:95], v[40:43], v[28:31], v[80:95]
  v_mfma_f32_32x32x16_bf16 v[96:111], v[44:47], v[24:27], v[96:111]
  v_mfma_f32_32x32x16_bf16 v[112:127], v[44:47], v[28:31], v[112:127]
  ds_read_b128 v[24:27], v139 offset:0
  ds_read_b128 v[28:31], v139 offset:4096
  ds_read_b64_tr_b16 v[40:41], v54 offset:12288
  ds_read_b64_tr_b16 v[42:43], v54 offset:13312
  ds_read_b64_tr_b16 v[44:45], v55 offset:12288
  ds_read_b64_tr_b16 v[46:47], v55 offset:13312
  s_waitcnt lgkmcnt(6)
  v_mfma_f32_32x32x16_bf16 v[64:79], v[32:35], v[16:19], v[64:79]
  v_mfma_f32_32x32x16_bf16 v[80:95], v[32:35], v[20:23], v[80:95]
  v_mfma_f32_32x32x16_bf16 v[96:111], v[36:39], v[16:19], v[96:111]
  v_mfma_f32_32x32x16_bf16 v[112:127], v[36:39], v[20:23], v[112:127]
  s_barrier
  ds_read_b128 v[16:19], v140 offset:0
  ds_read_b128 v[20:23], v140 offset:4096
  ds_read_b64_tr_b16 v[32:33], v54 offset:16384
  ds_read_b64_tr_b16 v[34:35], v54 offset:17408
  ds_read_b64_tr_b16 v[36:37], v55 offset:16384
  ds_read_b64_tr_b16 v[38:39], v55 offset:17408
  s_waitcnt lgkmcnt(6)
  v_mfma_f32_32x32x16_bf16 v[64:79], v[40:43], v[24:27], v[64:79]
  v_mfma_f32_32x32x16_bf16 v[80:95], v[40:43], v[28:31], v[80:95]
  v_mfma_f32_32x32x16_bf16 v[96:111], v[44:47], v[24:27], v[96:111]
  v_mfma_f32_32x32x16_bf16 v[112:127], v[44:47], v[28:31], v[112:127]
  ds_read_b128 v[24:27], v141 offset:0
  ds_read_b128 v[28:31], v141 offset:4096
  ds_read_b64_tr_b16 v[40:41], v54 offset:20480
  ds_read_b64_tr_b16 v[42:43], v54 offset:21504
  ds_read_b64_tr_b16 v[44:45], v55 offset:20480
  ds_read_b64_tr_b16 v[46:47], v55 offset:21504
  s_waitcnt lgkmcnt(6)
  v_mfma_f32_32x32x16_bf16 v[64:79], v[32:35], v[16:19], v[64:79]
  v_mfma_f32_32x32x16_bf16 v[80:95], v[32:35], v[20:23], v[80:95]
  v_mfma_f32_32x32x16_bf16 v[96:111], v[36:39], v[16:19], v[96:111]
  v_mfma_f32_32x32x16_bf16 v[112:127], v[36:39], v[20:23], v[112:127]
  s_barrier
  ds_read_b128 v[16:19], v142 offset:0
  ds_read_b128 v[20:23], v142 offset:4096
  ds_read_b64_tr_b16 v[32:33], v54 offset:24576
  ds_read_b64_tr_b16 v[34:35], v54 offset:25600
  ds_read_b64_tr_b16 v[36:37], v55 offset:24576
  ds_read_b64_tr_b16 v[38:39], v55 offset:25600
  s_waitcnt lgkmcnt(6)
  v_mfma_f32_32x32x16_bf16 v[64:79], v[40:43], v[24:27], v[64:79]
  v_mfma_f32_32x32x16_bf16 v[80:95], v[40:43], v[28:31], v[80:95]
  v_mfma_f32_32x32x16_bf16 v[96:111], v[44:47], v[24:27], v[96:111]
  v_mfma_f32_32x32x16_bf16 v[112:127], v[44:47], v[28:31], v[112:127]
  ds_read_b128 v[24:27], v143 offset:0
  ds_read_b128 v[28:31], v143 offset:4096
  ds_read_b64_tr_b16 v[40:41], v54 offset:28672
  ds_read_b64_tr_b16 v[42:43], v54 offset:29696
  ds_read_b64_tr_b16 v[44:45], v55 offset:28672
  ds_read_b64_tr_b16 v[46:47], v55 offset:29696
  s_waitcnt lgkmcnt(6)
  v_mfma_f32_32x32x16_bf16 v[64:79], v[32:35], v[16:19], v[64:79]
  v_mfma_f32_32x32x16_bf16 v[80:95], v[32:35], v[20:23], v[80:95]
  v_mfma_f32_32x32x16_bf16 v[96:111], v[36:39], v[16:19], v[96:111]
  v_mfma_f32_32x32x16_bf16 v[112:127], v[36:39], v[20:23], v[112:127]
  s_barrier
  ds_read_b128 v[16:19], v128 offset:0
  ds_read_b128 v[20:23], v128 offset:4096
  ds_read_b64_tr_b16 v[32:33], v54 offset:0
  ds_read_b64_tr_b16 v[34:35], v54 offset:1024
  ds_read_b64_tr_b16 v[36:37], v55 offset:0
  ds_read_b64_tr_b16 v[38:39], v55 offset:1024
  s_waitcnt lgkmcnt(6)
  v_mfma_f32_32x32x16_bf16 v[64:79], v[40:43], v[24:27], v[64:79]
  v_mfma_f32_32x32x16_bf16 v[80:95], v[40:43], v[28:31], v[80:95]
  v_mfma_f32_32x32x16_bf16 v[96:111], v[44:47], v[24:27], v[96:111]
  v_mfma_f32_32x32x16_bf16 v[112:127], v[44:47], v[28:31], v[112:127]
  ds_read_b128 v[24:27], v129 offset:0
  ds_read_b128 v[28:31], v129 offset:4096
  ds_read_b64_tr_b16 v[40:41], v54 offset:4096
  ds_read_b64_tr_b16 v[42:43], v54 offset:5120
  ds_read_b64_tr_b16 v[44:45], v55 offset:4096
  ds_read_b64_tr_b16 v[46:47], v55 offset:5120
  s_waitcnt lgkmcnt(6)
  v_mfma_f32_32x32x16_bf16 v[64:79], v[32:35], v[16:19], v[64:79]
  v_mfma_f32_32x32x16_bf16 v[80:95], v[32:35], v[20:23], v[80:95]
  v_mfma_f32_32x32x16_bf16 v[96:111], v[36:39], v[16:19], v[96:111]
  v_mfma_f32_32x32x16_bf16 v[112:127], v[36:39], v[20:23], v[112:127]
  s_barrier
  ds_read_b128 v[16:19], v130 offset:0
  ds_read_b128 v[20:23], v130 offset:4096
  ds_read_b64_tr_b16 v[32:33], v54 offset:8192
  ds_read_b64_tr_b16 v[34:35], v54 offset:9216
  ds_read_b64_tr_b16 v[36:37], v55 offset:8192
  ds_read_b64_tr_b16 v[38:39], v55 offset:9216
  s_waitcnt lgkmcnt(6)
  v_mfma_f32_32x32x16_bf16 v[64:79], v[40:43], v[24:27], v[64:79]
  v_mfma_f32_32x32x16_bf16 v[80:95], v[40:43], v[28:31], v[80:95]
  v_mfma_f32_32x32x16_bf16 v[96:111], v[44:47], v[24:27], v[96:111]
  v_mfma_f32_32x32x16_bf16 v[112:127], v[44:47], v[28:31], v[112:127]
  ds_read_b128 v[24:27], v131 offset:0
  ds_read_b128 v[28:31], v131 offset:4096
  ds_read_b64_tr_b16 v[40:41], v54 offset:12288
  ds_read_b64_tr_b16 v[42:43], v54 offset:13312
  ds_read_b64_tr_b16 v[44:45], v55 offset:12288
  ds_read_b64_tr_b16 v[46:47], v55 offset:13312
  s_waitcnt lgkmcnt(6)
  v_mfma_f32_32x32x16_bf16 v[64:79], v[32:35], v[16:19], v[64:79]
  v_mfma_f32_32x32x16_bf16 v[80:95], v[32:35], v[20:23], v[80:95]
  v_mfma_f32_32x32x16_bf16 v[96:111], v[36:39], v[16:19], v[96:111]
  v_mfma_f32_32x32x16_bf16 v[112:127], v[36:39], v[20:23], v[112:127]
  s_barrier
  ds_read_b128 v[16:19], v132 offset:0
  ds_read_b128 v[20:23], v132 offset:4096
  ds_read_b64_tr_b16 v[32:33], v54 offset:16384
  ds_read_b64_tr_b16 v[34:35], v54 offset:17408
  ds_read_b64_tr_b16 v[36:37], v55 offset:16384
  ds_read_b64_tr_b16 v[38:39], v55 offset:17408
  s_waitcnt lgkmcnt(6)
  v_mfma_f32_32x32x16_bf16 v[64:79], v[40:43], v[24:27], v[64:79]
  v_mfma_f32_32x32x16_bf16 v[80:95], v[40:43], v[28:31], v[80:95]
  v_mfma_f32_32x32x16_bf16 v[96:111], v[44:47], v[24:27], v[96:111]
  v_mfma_f32_32x32x16_bf16 v[112:127], v[44:47], v[28:31], v[112:127]
  ds_read_b128 v[24:27], v133 offset:0
  ds_read_b128 v[28:31], v133 offset:4096
  ds_read_b64_tr_b16 v[40:41], v54 offset:20480
  ds_read_b64_tr_b16 v[42:43], v54 offset:21504
  ds_read_b64_tr_b16 v[44:45], v55 offset:20480
  ds_read_b64_tr_b16 v[46:47], v55 offset:21504
  s_waitcnt lgkmcnt(6)
  v_mfma_f32_32x32x16_bf16 v[64:79], v[32:35], v[16:19], v[64:79]
  v_mfma_f32_32x32x16_bf16 v[80:95], v[32:35], v[20:23], v[80:95]
  v_mfma_f32_32x32x16_bf16 v[96:111], v[36:39], v[16:19], v[96:111]
  v_mfma_f32_32x32x16_bf16 v[112:127], v[36:39], v[20:23], v[112:127]
  s_barrier
  ds_read_b128 v[16:19], v134 offset:0
  ds_read_b128 v[20:23], v134 offset:4096
  ds_read_b64_tr_b16 v[32:33], v54 offset:24576
  ds_read_b64_tr_b16 v[34:35], v54 offset:25600
  ds_read_b64_tr_b16 v[36:37], v55 offset:24576
  ds_read_b64_tr_b16 v[38:39], v55 offset:25600
  s_waitcnt lgkmcnt(6)
  v_mfma_f32_32x32x16_bf16 v[64:79], v[40:43], v[24:27], v[64:79]
  v_mfma_f32_32x32x16_bf16 v[80:95], v[40:43], v[28:31], v[80:95]
  v_mfma_f32_32x32x16_bf16 v[96:111], v[44:47], v[24:27], v[96:111]
  v_mfma_f32_32x32x16_bf16 v[112:127], v[44:47], v[28:31], v[112:127]
  ds_read_b128 v[24:27], v135 offset:0
  ds_read_b128 v[28:31], v135 offset:4096
  ds_read_b64_tr_b16 v[40:41], v54 offset:28672
  ds_read_b64_tr_b16 v[42:43], v54 offset:29696
  ds_read_b64_tr_b16 v[44:45], v55 offset:28672
  ds_read_b64_tr_b16 v[46:47], v55 offset:29696
  s_waitcnt lgkmcnt(6)
  v_mfma_f32_32x32x16_bf16 v[64:79], v[32:35], v[16:19], v[64:79]
  v_mfma_f32_32x32x16_bf16 v[80:95], v[32:35], v[20:23], v[80:95]
  v_mfma_f32_32x32x16_bf16 v[96:111], v[36:39], v[16:19], v[96:111]
  v_mfma_f32_32x32x16_bf16 v[112:127], v[36:39], v[20:23], v[112:127]
  s_barrier
  ds_read_b128 v[16:19], v136 offset:0
  ds_read_b128 v[20:23], v136 offset:4096
  ds_read_b64_tr_b16 v[32:33], v54 offset:0
  ds_read_b64_tr_b16 v[34:35], v54 offset:1024
  ds_read_b64_tr_b16 v[36:37], v55 offset:0
  ds_read_b64_tr_b16 v[38:39], v55 offset:1024
  s_waitcnt lgkmcnt(6)
  v_mfma_f32_32x32x16_bf16 v[64:79], v[40:43], v[24:27], v[64:79]
  v_mfma_f32_32x32x16_bf16 v[80:95], v[40:43], v[28:31], v[80:95]
  v_mfma_f32_32x32x16_bf16 v[96:111], v[44:47], v[24:27], v[96:111]
  v_mfma_f32_32x32x16_bf16 v[112:127], v[44:47], v[28:31], v[112:127]
  ds_read_b128 v[24:27], v137 offset:0
  ds_read_b128 v[28:31], v137 offset:4096
  ds_read_b64_tr_b16 v[40:41], v54 offset:4096
  ds_read_b64_tr_b16 v[42:43], v54 offset:5120
  ds_read_b64_tr_b16 v[44:45], v55 offset:4096
  ds_read_b64_tr_b16 v[46:47], v55 offset:5120
  s_waitcnt lgkmcnt(6)
  v_mfma_f32_32x32x16_bf16 v[64:79], v[32:35], v[16:19], v[64:79]
  v_mfma_f32_32x32x16_bf16 v[80:95], v[32:35], v[20:23], v[80:95]
  v_mfma_f32_32x32x16_bf16 v[96:111], v[36:39], v[16:19], v[96:111]
  v_mfma_f32_32x32x16_bf16 v[112:127], v[36:39], v[20:23], v[112:127]
  s_barrier
  ds_read_b128 v[16:19], v138 offset:0
  ds_read_b128 v[20:23], v138 offset:4096
  ds_read_b64_tr_b16 v[32:33], v54 offset:8192
  ds_read_b64_tr_b16 v[34:35], v54 offset:9216
  ds_read_b64_tr_b16 v[36:37], v55 offset:8192
  ds_read_b64_tr_b16 v[38:39], v55 offset:9216
  s_waitcnt lgkmcnt(6)
  v_mfma_f32_32x32x16_bf16 v[64:79], v[40:43], v[24:27], v[64:79]
  v_mfma_f32_32x32x16_bf16 v[80:95], v[40:43], v[28:31], v[80:95]
  v_mfma_f32_32x32x16_bf16 v[96:111], v[44:47], v[24:27], v[96:111]
  v_mfma_f32_32x32x16_bf16 v[112:127], v[44:47], v[28:31], v[112:127]
  ds_read_b128 v[24:27], v139 offset:0
  ds_read_b128 v[28:31], v139 offset:4096
  ds_read_b64_tr_b16 v[40:41], v54 offset:12288
  ds_read_b64_tr_b16 v[42:43], v54 offset:13312
  ds_read_b64_tr_b16 v[44:45], v55 offset:12288
  ds_read_b64_tr_b16 v[46:47], v55 offset:13312
  s_waitcnt lgkmcnt(6)
  v_mfma_f32_32x32x16_bf16 v[64:79], v[32:35], v[16:19], v[64:79]
  v_mfma_f32_32x32x16_bf16 v[80:95], v[32:35], v[20:23], v[80:95]
  v_mfma_f32_32x32x16_bf16 v[96:111], v[36:39], v[16:19], v[96:111]
  v_mfma_f32_32x32x16_bf16 v[112:127], v[36:39], v[20:23], v[112:127]
  s_barrier
  ds_read_b128 v[16:19], v140 offset:0
  ds_read_b128 v[20:23], v140 offset:4096
  ds_read_b64_tr_b16 v[32:33], v54 offset:16384
  ds_read_b64_tr_b16 v[34:35], v54 offset:17408
  ds_read_b64_tr_b16 v[36:37], v55 offset:16384
  ds_read_b64_tr_b16 v[38:39], v55 offset:17408
  s_waitcnt lgkmcnt(6)
  v_mfma_f32_32x32x16_bf16 v[64:79], v[40:43], v[24:27], v[64:79]
  v_mfma_f32_32x32x16_bf16 v[80:95], v[40:43], v[28:31], v[80:95]
  v_mfma_f32_32x32x16_bf16 v[96:111], v[44:47], v[24:27], v[96:111]
  v_mfma_f32_32x32x16_bf16 v[112:127], v[44:47], v[28:31], v[112:127]
  ds_read_b128 v[24:27], v141 offset:0
  ds_read_b128 v[28:31], v141 offset:4096
  ds_read_b64_tr_b16 v[40:41], v54 offset:20480
  ds_read_b64_tr_b16 v[42:43], v54 offset:21504
  ds_read_b64_tr_b16 v[44:45], v55 offset:20480
  ds_read_b64_tr_b16 v[46:47], v55 offset:21504
  s_waitcnt lgkmcnt(6)
  v_mfma_f32_32x32x16_bf16 v[64:79], v[32:35], v[16:19], v[64:79]
  v_mfma_f32_32x32x16_bf16 v[80:95], v[32:35], v[20:23], v[80:95]
  v_mfma_f32_32x32x16_bf16 v[96:111], v[36:39], v[16:19], v[96:111]
  v_mfma_f32_32x32x16_bf16 v[112:127], v[36:39], v[20:23], v[112:127]
  s_barrier
  ds_read_b128 v[16:19], v142 offset:0
  ds_read_b128 v[20:23], v142 offset:4096
  ds_read_b64_tr_b16 v[32:33], v54 offset:24576
  ds_read_b64_tr_b16 v[34:35], v54 offset:25600
  ds_read_b64_tr_b16 v[36:37], v55 offset:24576
  ds_read_b64_tr_b16 v[38:39], v55 offset:25600
  s_waitcnt lgkmcnt(6)
  v_mfma_f32_32x32x16_bf16 v[64:79], v[40:43], v[24:27], v[64:79]
  v_mfma_f32_32x32x16_bf16 v[80:95], v[40:43], v[28:31], v[80:95]
  v_mfma_f32_32x32x16_bf16 v[96:111], v[44:47], v[24:27], v[96:111]
  v_mfma_f32_32x32x16_bf16 v[112:127], v[44:47], v[28:31], v[112:127]
  ds_read_b128 v[24:27], v143 offset:0
  ds_read_b128 v[28:31], v143 offset:4096
  ds_read_b64_tr_b16 v[40:41], v54 offset:28672
  ds_read_b64_tr_b16 v[42:43], v54 offset:29696
  ds_read_b64_tr_b16 v[44:45], v55 offset:28672
  ds_read_b64_tr_b16 v[46:47], v55 offset:29696
  s_waitcnt lgkmcnt(6)
  v_mfma_f32_32x32x16_bf16 v[64:79], v[32:35], v[16:19], v[64:79]
  v_mfma_f32_32x32x16_bf16 v[80:95], v[32:35], v[20:23], v[80:95]
  v_mfma_f32_32x32x16_bf16 v[96:111], v[36:39], v[16:19], v[96:111]
  v_mfma_f32_32x32x16_bf16 v[112:127], v[36:39], v[20:23], v[112:127]
  s_barrier
  ds_read_b128 v[16:19], v128 offset:0
  ds_read_b128 v[20:23], v128 offset:4096
  ds_read_b64_tr_b16 v[32:33], v54 offset:0
  ds_read_b64_tr_b16 v[34:35], v54 offset:1024
  ds_read_b64_tr_b16 v[36:37], v55 offset:0
  ds_read_b64_tr_b16 v[38:39], v55 offset:1024
  s_waitcnt lgkmcnt(6)
  v_mfma_f32_32x32x16_bf16 v[64:79], v[40:43], v[24:27], v[64:79]
  v_mfma_f32_32x32x16_bf16 v[80:95], v[40:43], v[28:31], v[80:95]
  v_mfma_f32_32x32x16_bf16 v[96:111], v[44:47], v[24:27], v[96:111]
  v_mfma_f32_32x32x16_bf16 v[112:127], v[44:47], v[28:31], v[112:127]
  ds_read_b128 v[24:27], v129 offset:0
  ds_read_b128 v[28:31], v129 offset:4096
  ds_read_b64_tr_b16 v[40:41], v54 offset:4096
  ds_read_b64_tr_b16 v[42:43], v54 offset:5120
  ds_read_b64_tr_b16 v[44:45], v55 offset:4096
  ds_read_b64_tr_b16 v[46:47], v55 offset:5120
  s_waitcnt lgkmcnt(6)
  v_mfma_f32_32x32x16_bf16 v[64:79], v[32:35], v[16:19], v[64:79]
  v_mfma_f32_32x32x16_bf16 v[80:95], v[32:35], v[20:23], v[80:95]
  v_mfma_f32_32x32x16_bf16 v[96:111], v[36:39], v[16:19], v[96:111]
  v_mfma_f32_32x32x16_bf16 v[112:127], v[36:39], v[20:23], v[112:127]
  s_barrier
  ds_read_b128 v[16:19], v130 offset:0
  ds_read_b128 v[20:23], v130 offset:4096
  ds_read_b64_tr_b16 v[32:33], v54 offset:8192
  ds_read_b64_tr_b16 v[34:35], v54 offset:9216
  ds_read_b64_tr_b16 v[36:37], v55 offset:8192
  ds_read_b64_tr_b16 v[38:39], v55 offset:9216
  s_waitcnt lgkmcnt(6)
  v_mfma_f32_32x32x16_bf16 v[64:79], v[40:43], v[24:27], v[64:79]
  v_mfma_f32_32x32x16_bf16 v[80:95], v[40:43], v[28:31], v[80:95]
  v_mfma_f32_32x32x16_bf16 v[96:111], v[44:47], v[24:27], v[96:111]
  v_mfma_f32_32x32x16_bf16 v[112:127], v[44:47], v[28:31], v[112:127]
  ds_read_b128 v[24:27], v131 offset:0
  ds_read_b128 v[28:31], v131 offset:4096
  ds_read_b64_tr_b16 v[40:41], v54 offset:12288
  ds_read_b64_tr_b16 v[42:43], v54 offset:13312
  ds_read_b64_tr_b16 v[44:45], v55 offset:12288
  ds_read_b64_tr_b16 v[46:47], v55 offset:13312
  s_waitcnt lgkmcnt(6)
  v_mfma_f32_32x32x16_bf16 v[64:79], v[32:35], v[16:19], v[64:79]
  v_mfma_f32_32x32x16_bf16 v[80:95], v[32:35], v[20:23], v[80:95]
  v_mfma_f32_32x32x16_bf16 v[96:111], v[36:39], v[16:19], v[96:111]
  v_mfma_f32_32x32x16_bf16 v[112:127], v[36:39], v[20:23], v[112:127]
  s_barrier
  ds_read_b128 v[16:19], v132 offset:0
  ds_read_b128 v[20:23], v132 offset:4096
  ds_read_b64_tr_b16 v[32:33], v54 offset:16384
  ds_read_b64_tr_b16 v[34:35], v54 offset:17408
  ds_read_b64_tr_b16 v[36:37], v55 offset:16384
  ds_read_b64_tr_b16 v[38:39], v55 offset:17408
  s_waitcnt lgkmcnt(6)
  v_mfma_f32_32x32x16_bf16 v[64:79], v[40:43], v[24:27], v[64:79]
  v_mfma_f32_32x32x16_bf16 v[80:95], v[40:43], v[28:31], v[80:95]
  v_mfma_f32_32x32x16_bf16 v[96:111], v[44:47], v[24:27], v[96:111]
  v_mfma_f32_32x32x16_bf16 v[112:127], v[44:47], v[28:31], v[112:127]
  ds_read_b128 v[24:27], v133 offset:0
  ds_read_b128 v[28:31], v133 offset:4096
  ds_read_b64_tr_b16 v[40:41], v54 offset:20480
  ds_read_b64_tr_b16 v[42:43], v54 offset:21504
  ds_read_b64_tr_b16 v[44:45], v55 offset:20480
  ds_read_b64_tr_b16 v[46:47], v55 offset:21504
  s_waitcnt lgkmcnt(6)
  v_mfma_f32_32x32x16_bf16 v[64:79], v[32:35], v[16:19], v[64:79]
  v_mfma_f32_32x32x16_bf16 v[80:95], v[32:35], v[20:23], v[80:95]
  v_mfma_f32_32x32x16_bf16 v[96:111], v[36:39], v[16:19], v[96:111]
  v_mfma_f32_32x32x16_bf16 v[112:127], v[36:39], v[20:23], v[112:127]
  s_barrier
  ds_read_b128 v[16:19], v134 offset:0
  ds_read_b128 v[20:23], v134 offset:4096
  ds_read_b64_tr_b16 v[32:33], v54 offset:24576
  ds_read_b64_tr_b16 v[34:35], v54 offset:25600
  ds_read_b64_tr_b16 v[36:37], v55 offset:24576
  ds_read_b64_tr_b16 v[38:39], v55 offset:25600
  s_waitcnt lgkmcnt(6)
  v_mfma_f32_32x32x16_bf16 v[64:79], v[40:43], v[24:27], v[64:79]
  v_mfma_f32_32x32x16_bf16 v[80:95], v[40:43], v[28:31], v[80:95]
  v_mfma_f32_32x32x16_bf16 v[96:111], v[44:47], v[24:27], v[96:111]
  v_mfma_f32_32x32x16_bf16 v[112:127], v[44:47], v[28:31], v[112:127]
  ds_read_b128 v[24:27], v135 offset:0
  ds_read_b128 v[28:31], v135 offset:4096
  ds_read_b64_tr_b16 v[40:41], v54 offset:28672
  ds_read_b64_tr_b16 v[42:43], v54 offset:29696
  ds_read_b64_tr_b16 v[44:45], v55 offset:28672
  ds_read_b64_tr_b16 v[46:47], v55 offset:29696
  s_waitcnt lgkmcnt(6)
  v_mfma_f32_32x32x16_bf16 v[64:79], v[32:35], v[16:19], v[64:79]
  v_mfma_f32_32x32x16_bf16 v[80:95], v[32:35], v[20:23], v[80:95]
  v_mfma_f32_32x32x16_bf16 v[96:111], v[36:39], v[16:19], v[96:111]
  v_mfma_f32_32x32x16_bf16 v[112:127], v[36:39], v[20:23], v[112:127]
  s_waitcnt lgkmcnt(0)
  v_mfma_f32_32x32x16_bf16 v[64:79], v[40:43], v[24:27], v[64:79]
  v_mfma_f32_32x32x16_bf16 v[80:95], v[40:43], v[28:31], v[80:95]
  v_mfma_f32_32x32x16_bf16 v[96:111], v[44:47], v[24:27], v[96:111]
  v_mfma_f32_32x32x16_bf16 v[112:127], v[44:47], v[28:31], v[112:127]
  s_nop 11
  v_cmp_lt_u32 s[40:41], 31, v1
  s_cmp_lt_u32 s12, 5
  s_mov_b32 s60, 196608
  s_cselect_b32 s42, 98304, s60
  s_mov_b32 s60, 3072
  s_cselect_b32 s43, 1536, s60
  s_cselect_b32 s44, 0, 3145728
  s_mov_b32 s60, 19922944
  s_cselect_b32 s45, 16777216, s60
  s_cselect_b32 s46, 0, 5
  s_cselect_b32 s47, 1051011932, 1.0
  s_cmp_eq_u32 s9, 0
  s_cselect_b32 s44, s44, s45
  s_cselect_b32 s47, s47, 1.0
  s_sub_u32 s46, s12, s46
  s_lshl_b32 s46, s46, 5
  s_lshl_b32 s48, s14, 4
  s_add_u32 s46, s46, s48
  s_lshl_b32 s48, s11, 3
  s_lshl_b32 s49, s13, 1
  s_add_u32 s48, s48, s49
  s_mul_i32 s48, s48, s43
  s_add_u32 s44, s44, s48
  s_add_u32 s57, s44, s43
  v_and_b32 v4, 31, v1
  v_lshlrev_b32 v4, 4, v4
  v_mul_f32 v64, s47, v64
  v_mul_f32 v65, s47, v65
  v_mul_f32 v66, s47, v66
  v_mul_f32 v67, s47, v67
  v_mul_f32 v68, s47, v68
  v_mul_f32 v69, s47, v69
  v_mul_f32 v70, s47, v70
  v_mul_f32 v71, s47, v71
  v_mul_f32 v72, s47, v72
  v_mul_f32 v73, s47, v73
  v_mul_f32 v74, s47, v74
  v_mul_f32 v75, s47, v75
  v_mul_f32 v76, s47, v76
  v_mul_f32 v77, s47, v77
  v_mul_f32 v78, s47, v78
  v_mul_f32 v79, s47, v79
  v_mul_f32 v80, s47, v80
  v_mul_f32 v81, s47, v81
  v_mul_f32 v82, s47, v82
  v_mul_f32 v83, s47, v83
  v_mul_f32 v84, s47, v84
  v_mul_f32 v85, s47, v85
  v_mul_f32 v86, s47, v86
  v_mul_f32 v87, s47, v87
  v_mul_f32 v88, s47, v88
  v_mul_f32 v89, s47, v89
  v_mul_f32 v90, s47, v90
  v_mul_f32 v91, s47, v91
  v_mul_f32 v92, s47, v92
  v_mul_f32 v93, s47, v93
  v_mul_f32 v94, s47, v94
  v_mul_f32 v95, s47, v95
  v_mul_f32 v96, s47, v96
  v_mul_f32 v97, s47, v97
  v_mul_f32 v98, s47, v98
  v_mul_f32 v99, s47, v99
  v_mul_f32 v100, s47, v100
  v_mul_f32 v101, s47, v101
  v_mul_f32 v102, s47, v102
  v_mul_f32 v103, s47, v103
  v_mul_f32 v104, s47, v104
  v_mul_f32 v105, s47, v105
  v_mul_f32 v106, s47, v106
  v_mul_f32 v107, s47, v107
  v_mul_f32 v108, s47, v108
  v_mul_f32 v109, s47, v109
  v_mul_f32 v110, s47, v110
  v_mul_f32 v111, s47, v111
  v_mul_f32 v112, s47, v112
  v_mul_f32 v113, s47, v113
  v_mul_f32 v114, s47, v114
  v_mul_f32 v115, s47, v115
  v_mul_f32 v116, s47, v116
  v_mul_f32 v117, s47, v117
  v_mul_f32 v118, s47, v118
  v_mul_f32 v119, s47, v119
  v_mul_f32 v120, s47, v120
  v_mul_f32 v121, s47, v121
  v_mul_f32 v122, s47, v122
  v_mul_f32 v123, s47, v123
  v_mul_f32 v124, s47, v124
  v_mul_f32 v125, s47, v125
  v_mul_f32 v126, s47, v126
  v_mul_f32 v127, s47, v127
  s_mov_b32 s52, 0xcccccccd
  v_mov_b32 v12, 0x3f80
  v_mov_b32 v13, 0
  s_add_u32 s54, s46, 0
  s_mul_hi_u32 s50, s54, s52
  s_lshr_b32 s50, s50, 2
  s_mul_i32 s51, s50, 5
  s_sub_u32 s51, s54, s51
  s_mul_i32 s55, s50, s42
  s_lshr_b32 s53, s51, 1
  s_lshl_b32 s53, s53, 9
  s_add_u32 s55, s55, s53
  s_and_b32 s53, s51, 1
  s_lshl_b32 s53, s53, 3
  s_add_u32 s55, s55, s53
  s_mov_b32 s58, s51
  s_add_u32 s54, s54, 1
  s_mul_hi_u32 s50, s54, s52
  s_lshr_b32 s50, s50, 2
  s_mul_i32 s51, s50, 5
  s_sub_u32 s51, s54, s51
  s_mul_i32 s56, s50, s42
  s_lshr_b32 s53, s51, 1
  s_lshl_b32 s53, s53, 9
  s_add_u32 s56, s56, s53
  s_and_b32 s53, s51, 1
  s_lshl_b32 s53, s53, 3
  s_add_u32 s56, s56, s53
  s_mov_b32 s59, s51
  v_mov_b32 v5, s55
  v_mov_b32 v6, s56
  v_cndmask_b32 v5, v5, v6, s[40:41]
  v_add_u32 v5, v5, v4
  v_cvt_pk_bf16_f32 v16, v64, v65
  v_cvt_pk_bf16_f32 v17, v66, v67
  buffer_store_dwordx2 v[16:17], v5, s[4:7], s44 offen
  v_cvt_pk_bf16_f32 v18, v80, v81
  v_cvt_pk_bf16_f32 v19, v82, v83
  buffer_store_dwordx2 v[18:19], v5, s[4:7], s57 offen
  s_cmp_lt_u32 s12, 5
  s_cbranch_scc1 L_proj_kernel_kc00
  s_cmp_eq_u32 s58, 4
  s_cselect_b32 s60, -1, 0
  s_cmp_eq_u32 s59, 4
  s_cselect_b32 s61, -1, 0
  s_or_b32 s49, s60, s61
  s_cmp_eq_u32 s49, 0
  s_cbranch_scc1 L_proj_kernel_kc00
  s_mov_b64 exec, s[60:61]
  buffer_store_dwordx2 v[12:13], v5, s[4:7], s44 offen offset:8
  buffer_store_dwordx2 v[12:13], v5, s[4:7], s57 offen offset:8
  s_mov_b64 exec, -1
L_proj_kernel_kc00:
  s_add_u32 s54, s46, 2
  s_mul_hi_u32 s50, s54, s52
  s_lshr_b32 s50, s50, 2
  s_mul_i32 s51, s50, 5
  s_sub_u32 s51, s54, s51
  s_mul_i32 s55, s50, s42
  s_lshr_b32 s53, s51, 1
  s_lshl_b32 s53, s53, 9
  s_add_u32 s55, s55, s53
  s_and_b32 s53, s51, 1
  s_lshl_b32 s53, s53, 3
  s_add_u32 s55, s55, s53
  s_mov_b32 s58, s51
  s_add_u32 s54, s54, 1
  s_mul_hi_u32 s50, s54, s52
  s_lshr_b32 s50, s50, 2
  s_mul_i32 s51, s50, 5
  s_sub_u32 s51, s54, s51
  s_mul_i32 s56, s50, s42
  s_lshr_b32 s53, s51, 1
  s_lshl_b32 s53, s53, 9
  s_add_u32 s56, s56, s53
  s_and_b32 s53, s51, 1
  s_lshl_b32 s53, s53, 3
  s_add_u32 s56, s56, s53
  s_mov_b32 s59, s51
  v_mov_b32 v5, s55
  v_mov_b32 v6, s56
  v_cndmask_b32 v5, v5, v6, s[40:41]
  v_add_u32 v5, v5, v4
  v_cvt_pk_bf16_f32 v20, v68, v69
  v_cvt_pk_bf16_f32 v21, v70, v71
  buffer_store_dwordx2 v[20:21], v5, s[4:7], s44 offen
  v_cvt_pk_bf16_f32 v22, v84, v85
  v_cvt_pk_bf16_f32 v23, v86, v87
  buffer_store_dwordx2 v[22:23], v5, s[4:7], s57 offen
  s_cmp_lt_u32 s12, 5
  s_cbranch_scc1 L_proj_kernel_kc01
  s_cmp_eq_u32 s58, 4
  s_cselect_b32 s60, -1, 0
  s_cmp_eq_u32 s59, 4
  s_cselect_b32 s61, -1, 0
  s_or_b32 s49, s60, s61
  s_cmp_eq_u32 s49, 0
  s_cbranch_scc1 L_proj_kernel_kc01
  s_mov_b64 exec, s[60:61]
  buffer_store_dwordx2 v[12:13], v5, s[4:7], s44 offen offset:8
  buffer_store_dwordx2 v[12:13], v5, s[4:7], s57 offen offset:8
  s_mov_b64 exec, -1
L_proj_kernel_kc01:
  s_add_u32 s54, s46, 4
  s_mul_hi_u32 s50, s54, s52
  s_lshr_b32 s50, s50, 2
  s_mul_i32 s51, s50, 5
  s_sub_u32 s51, s54, s51
  s_mul_i32 s55, s50, s42
  s_lshr_b32 s53, s51, 1
  s_lshl_b32 s53, s53, 9
  s_add_u32 s55, s55, s53
  s_and_b32 s53, s51, 1
  s_lshl_b32 s53, s53, 3
  s_add_u32 s55, s55, s53
  s_mov_b32 s58, s51
  s_add_u32 s54, s54, 1
  s_mul_hi_u32 s50, s54, s52
  s_lshr_b32 s50, s50, 2
  s_mul_i32 s51, s50, 5
  s_sub_u32 s51, s54, s51
  s_mul_i32 s56, s50, s42
  s_lshr_b32 s53, s51, 1
  s_lshl_b32 s53, s53, 9
  s_add_u32 s56, s56, s53
  s_and_b32 s53, s51, 1
  s_lshl_b32 s53, s53, 3
  s_add_u32 s56, s56, s53
  s_mov_b32 s59, s51
  v_mov_b32 v5, s55
  v_mov_b32 v6, s56
  v_cndmask_b32 v5, v5, v6, s[40:41]
  v_add_u32 v5, v5, v4
  v_cvt_pk_bf16_f32 v24, v72, v73
  v_cvt_pk_bf16_f32 v25, v74, v75
  buffer_store_dwordx2 v[24:25], v5, s[4:7], s44 offen
  v_cvt_pk_bf16_f32 v26, v88, v89
  v_cvt_pk_bf16_f32 v27, v90, v91
  buffer_store_dwordx2 v[26:27], v5, s[4:7], s57 offen
  s_cmp_lt_u32 s12, 5
  s_cbranch_scc1 L_proj_kernel_kc02
  s_cmp_eq_u32 s58, 4
  s_cselect_b32 s60, -1, 0
  s_cmp_eq_u32 s59, 4
  s_cselect_b32 s61, -1, 0
  s_or_b32 s49, s60, s61
  s_cmp_eq_u32 s49, 0
  s_cbranch_scc1 L_proj_kernel_kc02
  s_mov_b64 exec, s[60:61]
  buffer_store_dwordx2 v[12:13], v5, s[4:7], s44 offen offset:8
  buffer_store_dwordx2 v[12:13], v5, s[4:7], s57 offen offset:8
  s_mov_b64 exec, -1
L_proj_kernel_kc02:
  s_add_u32 s54, s46, 6
  s_mul_hi_u32 s50, s54, s52
  s_lshr_b32 s50, s50, 2
  s_mul_i32 s51, s50, 5
  s_sub_u32 s51, s54, s51
  s_mul_i32 s55, s50, s42
  s_lshr_b32 s53, s51, 1
  s_lshl_b32 s53, s53, 9
  s_add_u32 s55, s55, s53
  s_and_b32 s53, s51, 1
  s_lshl_b32 s53, s53, 3
  s_add_u32 s55, s55, s53
  s_mov_b32 s58, s51
  s_add_u32 s54, s54, 1
  s_mul_hi_u32 s50, s54, s52
  s_lshr_b32 s50, s50, 2
  s_mul_i32 s51, s50, 5
  s_sub_u32 s51, s54, s51
  s_mul_i32 s56, s50, s42
  s_lshr_b32 s53, s51, 1
  s_lshl_b32 s53, s53, 9
  s_add_u32 s56, s56, s53
  s_and_b32 s53, s51, 1
  s_lshl_b32 s53, s53, 3
  s_add_u32 s56, s56, s53
  s_mov_b32 s59, s51
  v_mov_b32 v5, s55
  v_mov_b32 v6, s56
  v_cndmask_b32 v5, v5, v6, s[40:41]
  v_add_u32 v5, v5, v4
  v_cvt_pk_bf16_f32 v28, v76, v77
  v_cvt_pk_bf16_f32 v29, v78, v79
  buffer_store_dwordx2 v[28:29], v5, s[4:7], s44 offen
  v_cvt_pk_bf16_f32 v30, v92, v93
  v_cvt_pk_bf16_f32 v31, v94, v95
  buffer_store_dwordx2 v[30:31], v5, s[4:7], s57 offen
  s_cmp_lt_u32 s12, 5
  s_cbranch_scc1 L_proj_kernel_kc03
  s_cmp_eq_u32 s58, 4
  s_cselect_b32 s60, -1, 0
  s_cmp_eq_u32 s59, 4
  s_cselect_b32 s61, -1, 0
  s_or_b32 s49, s60, s61
  s_cmp_eq_u32 s49, 0
  s_cbranch_scc1 L_proj_kernel_kc03
  s_mov_b64 exec, s[60:61]
  buffer_store_dwordx2 v[12:13], v5, s[4:7], s44 offen offset:8
  buffer_store_dwordx2 v[12:13], v5, s[4:7], s57 offen offset:8
  s_mov_b64 exec, -1
L_proj_kernel_kc03:
  s_add_u32 s54, s46, 8
  s_mul_hi_u32 s50, s54, s52
  s_lshr_b32 s50, s50, 2
  s_mul_i32 s51, s50, 5
  s_sub_u32 s51, s54, s51
  s_mul_i32 s55, s50, s42
  s_lshr_b32 s53, s51, 1
  s_lshl_b32 s53, s53, 9
  s_add_u32 s55, s55, s53
  s_and_b32 s53, s51, 1
  s_lshl_b32 s53, s53, 3
  s_add_u32 s55, s55, s53
  s_mov_b32 s58, s51
  s_add_u32 s54, s54, 1
  s_mul_hi_u32 s50, s54, s52
  s_lshr_b32 s50, s50, 2
  s_mul_i32 s51, s50, 5
  s_sub_u32 s51, s54, s51
  s_mul_i32 s56, s50, s42
  s_lshr_b32 s53, s51, 1
  s_lshl_b32 s53, s53, 9
  s_add_u32 s56, s56, s53
  s_and_b32 s53, s51, 1
  s_lshl_b32 s53, s53, 3
  s_add_u32 s56, s56, s53
  s_mov_b32 s59, s51
  v_mov_b32 v5, s55
  v_mov_b32 v6, s56
  v_cndmask_b32 v5, v5, v6, s[40:41]
  v_add_u32 v5, v5, v4
  v_cvt_pk_bf16_f32 v16, v96, v97
  v_cvt_pk_bf16_f32 v17, v98, v99
  buffer_store_dwordx2 v[16:17], v5, s[4:7], s44 offen
  v_cvt_pk_bf16_f32 v18, v112, v113
  v_cvt_pk_bf16_f32 v19, v114, v115
  buffer_store_dwordx2 v[18:19], v5, s[4:7], s57 offen
  s_cmp_lt_u32 s12, 5
  s_cbranch_scc1 L_proj_kernel_kc10
  s_cmp_eq_u32 s58, 4
  s_cselect_b32 s60, -1, 0
  s_cmp_eq_u32 s59, 4
  s_cselect_b32 s61, -1, 0
  s_or_b32 s49, s60, s61
  s_cmp_eq_u32 s49, 0
  s_cbranch_scc1 L_proj_kernel_kc10
  s_mov_b64 exec, s[60:61]
  buffer_store_dwordx2 v[12:13], v5, s[4:7], s44 offen offset:8
  buffer_store_dwordx2 v[12:13], v5, s[4:7], s57 offen offset:8
  s_mov_b64 exec, -1
L_proj_kernel_kc10:
  s_add_u32 s54, s46, 10
  s_mul_hi_u32 s50, s54, s52
  s_lshr_b32 s50, s50, 2
  s_mul_i32 s51, s50, 5
  s_sub_u32 s51, s54, s51
  s_mul_i32 s55, s50, s42
  s_lshr_b32 s53, s51, 1
  s_lshl_b32 s53, s53, 9
  s_add_u32 s55, s55, s53
  s_and_b32 s53, s51, 1
  s_lshl_b32 s53, s53, 3
  s_add_u32 s55, s55, s53
  s_mov_b32 s58, s51
  s_add_u32 s54, s54, 1
  s_mul_hi_u32 s50, s54, s52
  s_lshr_b32 s50, s50, 2
  s_mul_i32 s51, s50, 5
  s_sub_u32 s51, s54, s51
  s_mul_i32 s56, s50, s42
  s_lshr_b32 s53, s51, 1
  s_lshl_b32 s53, s53, 9
  s_add_u32 s56, s56, s53
  s_and_b32 s53, s51, 1
  s_lshl_b32 s53, s53, 3
  s_add_u32 s56, s56, s53
  s_mov_b32 s59, s51
  v_mov_b32 v5, s55
  v_mov_b32 v6, s56
  v_cndmask_b32 v5, v5, v6, s[40:41]
  v_add_u32 v5, v5, v4
  v_cvt_pk_bf16_f32 v20, v100, v101
  v_cvt_pk_bf16_f32 v21, v102, v103
  buffer_store_dwordx2 v[20:21], v5, s[4:7], s44 offen
  v_cvt_pk_bf16_f32 v22, v116, v117
  v_cvt_pk_bf16_f32 v23, v118, v119
  buffer_store_dwordx2 v[22:23], v5, s[4:7], s57 offen
  s_cmp_lt_u32 s12, 5
  s_cbranch_scc1 L_proj_kernel_kc11
  s_cmp_eq_u32 s58, 4
  s_cselect_b32 s60, -1, 0
  s_cmp_eq_u32 s59, 4
  s_cselect_b32 s61, -1, 0
  s_or_b32 s49, s60, s61
  s_cmp_eq_u32 s49, 0
  s_cbranch_scc1 L_proj_kernel_kc11
  s_mov_b64 exec, s[60:61]
  buffer_store_dwordx2 v[12:13], v5, s[4:7], s44 offen offset:8
  buffer_store_dwordx2 v[12:13], v5, s[4:7], s57 offen offset:8
  s_mov_b64 exec, -1
L_proj_kernel_kc11:
  s_add_u32 s54, s46, 12
  s_mul_hi_u32 s50, s54, s52
  s_lshr_b32 s50, s50, 2
  s_mul_i32 s51, s50, 5
  s_sub_u32 s51, s54, s51
  s_mul_i32 s55, s50, s42
  s_lshr_b32 s53, s51, 1
  s_lshl_b32 s53, s53, 9
  s_add_u32 s55, s55, s53
  s_and_b32 s53, s51, 1
  s_lshl_b32 s53, s53, 3
  s_add_u32 s55, s55, s53
  s_mov_b32 s58, s51
  s_add_u32 s54, s54, 1
  s_mul_hi_u32 s50, s54, s52
  s_lshr_b32 s50, s50, 2
  s_mul_i32 s51, s50, 5
  s_sub_u32 s51, s54, s51
  s_mul_i32 s56, s50, s42
  s_lshr_b32 s53, s51, 1
  s_lshl_b32 s53, s53, 9
  s_add_u32 s56, s56, s53
  s_and_b32 s53, s51, 1
  s_lshl_b32 s53, s53, 3
  s_add_u32 s56, s56, s53
  s_mov_b32 s59, s51
  v_mov_b32 v5, s55
  v_mov_b32 v6, s56
  v_cndmask_b32 v5, v5, v6, s[40:41]
  v_add_u32 v5, v5, v4
  v_cvt_pk_bf16_f32 v24, v104, v105
  v_cvt_pk_bf16_f32 v25, v106, v107
  buffer_store_dwordx2 v[24:25], v5, s[4:7], s44 offen
  v_cvt_pk_bf16_f32 v26, v120, v121
  v_cvt_pk_bf16_f32 v27, v122, v123
  buffer_store_dwordx2 v[26:27], v5, s[4:7], s57 offen
  s_cmp_lt_u32 s12, 5
  s_cbranch_scc1 L_proj_kernel_kc12
  s_cmp_eq_u32 s58, 4
  s_cselect_b32 s60, -1, 0
  s_cmp_eq_u32 s59, 4
  s_cselect_b32 s61, -1, 0
  s_or_b32 s49, s60, s61
  s_cmp_eq_u32 s49, 0
  s_cbranch_scc1 L_proj_kernel_kc12
  s_mov_b64 exec, s[60:61]
  buffer_store_dwordx2 v[12:13], v5, s[4:7], s44 offen offset:8
  buffer_store_dwordx2 v[12:13], v5, s[4:7], s57 offen offset:8
  s_mov_b64 exec, -1
L_proj_kernel_kc12:
  s_add_u32 s54, s46, 14
  s_mul_hi_u32 s50, s54, s52
  s_lshr_b32 s50, s50, 2
  s_mul_i32 s51, s50, 5
  s_sub_u32 s51, s54, s51
  s_mul_i32 s55, s50, s42
  s_lshr_b32 s53, s51, 1
  s_lshl_b32 s53, s53, 9
  s_add_u32 s55, s55, s53
  s_and_b32 s53, s51, 1
  s_lshl_b32 s53, s53, 3
  s_add_u32 s55, s55, s53
  s_mov_b32 s58, s51
  s_add_u32 s54, s54, 1
  s_mul_hi_u32 s50, s54, s52
  s_lshr_b32 s50, s50, 2
  s_mul_i32 s51, s50, 5
  s_sub_u32 s51, s54, s51
  s_mul_i32 s56, s50, s42
  s_lshr_b32 s53, s51, 1
  s_lshl_b32 s53, s53, 9
  s_add_u32 s56, s56, s53
  s_and_b32 s53, s51, 1
  s_lshl_b32 s53, s53, 3
  s_add_u32 s56, s56, s53
  s_mov_b32 s59, s51
  v_mov_b32 v5, s55
  v_mov_b32 v6, s56
  v_cndmask_b32 v5, v5, v6, s[40:41]
  v_add_u32 v5, v5, v4
  v_cvt_pk_bf16_f32 v28, v108, v109
  v_cvt_pk_bf16_f32 v29, v110, v111
  buffer_store_dwordx2 v[28:29], v5, s[4:7], s44 offen
  v_cvt_pk_bf16_f32 v30, v124, v125
  v_cvt_pk_bf16_f32 v31, v126, v127
  buffer_store_dwordx2 v[30:31], v5, s[4:7], s57 offen
  s_cmp_lt_u32 s12, 5
  s_cbranch_scc1 L_proj_kernel_kc13
  s_cmp_eq_u32 s58, 4
  s_cselect_b32 s60, -1, 0
  s_cmp_eq_u32 s59, 4
  s_cselect_b32 s61, -1, 0
  s_or_b32 s49, s60, s61
  s_cmp_eq_u32 s49, 0
  s_cbranch_scc1 L_proj_kernel_kc13
  s_mov_b64 exec, s[60:61]
  buffer_store_dwordx2 v[12:13], v5, s[4:7], s44 offen offset:8
  buffer_store_dwordx2 v[12:13], v5, s[4:7], s57 offen offset:8
  s_mov_b64 exec, -1
L_proj_kernel_kc13:
  s_branch L_proj_kernel_end
L_proj_kernel_v:
  s_nop 4
  s_barrier
  ds_read_b128 v[16:19], v128 offset:0
  ds_read_b128 v[20:23], v128 offset:4096
  ds_read_b64_tr_b16 v[32:33], v54 offset:0
  ds_read_b64_tr_b16 v[34:35], v54 offset:1024
  ds_read_b64_tr_b16 v[36:37], v55 offset:0
  ds_read_b64_tr_b16 v[38:39], v55 offset:1024
  ds_read_b128 v[24:27], v129 offset:0
  ds_read_b128 v[28:31], v129 offset:4096
  ds_read_b64_tr_b16 v[40:41], v54 offset:4096
  ds_read_b64_tr_b16 v[42:43], v54 offset:5120
  ds_read_b64_tr_b16 v[44:45], v55 offset:4096
  ds_read_b64_tr_b16 v[46:47], v55 offset:5120
  s_waitcnt lgkmcnt(6)
  v_mfma_f32_32x32x16_bf16 v[64:79], v[16:19], v[32:35], v[64:79]
  v_mfma_f32_32x32x16_bf16 v[80:95], v[16:19], v[36:39], v[80:95]
  v_mfma_f32_32x32x16_bf16 v[96:111], v[20:23], v[32:35], v[96:111]
  v_mfma_f32_32x32x16_bf16 v[112:127], v[20:23], v[36:39], v[112:127]
  s_barrier
  ds_read_b128 v[16:19], v130 offset:0
  ds_read_b128 v[20:23], v130 offset:4096
  ds_read_b64_tr_b16 v[32:33], v54 offset:8192
  ds_read_b64_tr_b16 v[34:35], v54 offset:9216
  ds_read_b64_tr_b16 v[36:37], v55 offset:8192
  ds_read_b64_tr_b16 v[38:39], v55 offset:9216
  s_waitcnt lgkmcnt(6)
  v_mfma_f32_32x32x16_bf16 v[64:79], v[24:27], v[40:43], v[64:79]
  v_mfma_f32_32x32x16_bf16 v[80:95], v[24:27], v[44:47], v[80:95]
  v_mfma_f32_32x32x16_bf16 v[96:111], v[28:31], v[40:43], v[96:111]
  v_mfma_f32_32x32x16_bf16 v[112:127], v[28:31], v[44:47], v[112:127]
  ds_read_b128 v[24:27], v131 offset:0
  ds_read_b128 v[28:31], v131 offset:4096
  ds_read_b64_tr_b16 v[40:41], v54 offset:12288
  ds_read_b64_tr_b16 v[42:43], v54 offset:13312
  ds_read_b64_tr_b16 v[44:45], v55 offset:12288
  ds_read_b64_tr_b16 v[46:47], v55 offset:13312
  s_waitcnt lgkmcnt(6)
  v_mfma_f32_32x32x16_bf16 v[64:79], v[16:19], v[32:35], v[64:79]
  v_mfma_f32_32x32x16_bf16 v[80:95], v[16:19], v[36:39], v[80:95]
  v_mfma_f32_32x32x16_bf16 v[96:111], v[20:23], v[32:35], v[96:111]
  v_mfma_f32_32x32x16_bf16 v[112:127], v[20:23], v[36:39], v[112:127]
  s_barrier
  ds_read_b128 v[16:19], v132 offset:0
  ds_read_b128 v[20:23], v132 offset:4096
  ds_read_b64_tr_b16 v[32:33], v54 offset:16384
  ds_read_b64_tr_b16 v[34:35], v54 offset:17408
  ds_read_b64_tr_b16 v[36:37], v55 offset:16384
  ds_read_b64_tr_b16 v[38:39], v55 offset:17408
  s_waitcnt lgkmcnt(6)
  v_mfma_f32_32x32x16_bf16 v[64:79], v[24:27], v[40:43], v[64:79]
  v_mfma_f32_32x32x16_bf16 v[80:95], v[24:27], v[44:47], v[80:95]
  v_mfma_f32_32x32x16_bf16 v[96:111], v[28:31], v[40:43], v[96:111]
  v_mfma_f32_32x32x16_bf16 v[112:127], v[28:31], v[44:47], v[112:127]
  ds_read_b128 v[24:27], v133 offset:0
  ds_read_b128 v[28:31], v133 offset:4096
  ds_read_b64_tr_b16 v[40:41], v54 offset:20480
  ds_read_b64_tr_b16 v[42:43], v54 offset:21504
  ds_read_b64_tr_b16 v[44:45], v55 offset:20480
  ds_read_b64_tr_b16 v[46:47], v55 offset:21504
  s_waitcnt lgkmcnt(6)
  v_mfma_f32_32x32x16_bf16 v[64:79], v[16:19], v[32:35], v[64:79]
  v_mfma_f32_32x32x16_bf16 v[80:95], v[16:19], v[36:39], v[80:95]
  v_mfma_f32_32x32x16_bf16 v[96:111], v[20:23], v[32:35], v[96:111]
  v_mfma_f32_32x32x16_bf16 v[112:127], v[20:23], v[36:39], v[112:127]
  s_barrier
  ds_read_b128 v[16:19], v134 offset:0
  ds_read_b128 v[20:23], v134 offset:4096
  ds_read_b64_tr_b16 v[32:33], v54 offset:24576
  ds_read_b64_tr_b16 v[34:35], v54 offset:25600
  ds_read_b64_tr_b16 v[36:37], v55 offset:24576
  ds_read_b64_tr_b16 v[38:39], v55 offset:25600
  s_waitcnt lgkmcnt(6)
  v_mfma_f32_32x32x16_bf16 v[64:79], v[24:27], v[40:43], v[64:79]
  v_mfma_f32_32x32x16_bf16 v[80:95], v[24:27], v[44:47], v[80:95]
  v_mfma_f32_32x32x16_bf16 v[96:111], v[28:31], v[40:43], v[96:111]
  v_mfma_f32_32x32x16_bf16 v[112:127], v[28:31], v[44:47], v[112:127]
  ds_read_b128 v[24:27], v135 offset:0
  ds_read_b128 v[28:31], v135 offset:4096
  ds_read_b64_tr_b16 v[40:41], v54 offset:28672
  ds_read_b64_tr_b16 v[42:43], v54 offset:29696
  ds_read_b64_tr_b16 v[44:45], v55 offset:28672
  ds_read_b64_tr_b16 v[46:47], v55 offset:29696
  s_waitcnt lgkmcnt(6)
  v_mfma_f32_32x32x16_bf16 v[64:79], v[16:19], v[32:35], v[64:79]
  v_mfma_f32_32x32x16_bf16 v[80:95], v[16:19], v[36:39], v[80:95]
  v_mfma_f32_32x32x16_bf16 v[96:111], v[20:23], v[32:35], v[96:111]
  v_mfma_f32_32x32x16_bf16 v[112:127], v[20:23], v[36:39], v[112:127]
  s_barrier
  ds_read_b128 v[16:19], v136 offset:0
  ds_read_b128 v[20:23], v136 offset:4096
  ds_read_b64_tr_b16 v[32:33], v54 offset:0
  ds_read_b64_tr_b16 v[34:35], v54 offset:1024
  ds_read_b64_tr_b16 v[36:37], v55 offset:0
  ds_read_b64_tr_b16 v[38:39], v55 offset:1024
  s_waitcnt lgkmcnt(6)
  v_mfma_f32_32x32x16_bf16 v[64:79], v[24:27], v[40:43], v[64:79]
  v_mfma_f32_32x32x16_bf16 v[80:95], v[24:27], v[44:47], v[80:95]
  v_mfma_f32_32x32x16_bf16 v[96:111], v[28:31], v[40:43], v[96:111]
  v_mfma_f32_32x32x16_bf16 v[112:127], v[28:31], v[44:47], v[112:127]
  ds_read_b128 v[24:27], v137 offset:0
  ds_read_b128 v[28:31], v137 offset:4096
  ds_read_b64_tr_b16 v[40:41], v54 offset:4096
  ds_read_b64_tr_b16 v[42:43], v54 offset:5120
  ds_read_b64_tr_b16 v[44:45], v55 offset:4096
  ds_read_b64_tr_b16 v[46:47], v55 offset:5120
  s_waitcnt lgkmcnt(6)
  v_mfma_f32_32x32x16_bf16 v[64:79], v[16:19], v[32:35], v[64:79]
  v_mfma_f32_32x32x16_bf16 v[80:95], v[16:19], v[36:39], v[80:95]
  v_mfma_f32_32x32x16_bf16 v[96:111], v[20:23], v[32:35], v[96:111]
  v_mfma_f32_32x32x16_bf16 v[112:127], v[20:23], v[36:39], v[112:127]
  s_barrier
  ds_read_b128 v[16:19], v138 offset:0
  ds_read_b128 v[20:23], v138 offset:4096
  ds_read_b64_tr_b16 v[32:33], v54 offset:8192
  ds_read_b64_tr_b16 v[34:35], v54 offset:9216
  ds_read_b64_tr_b16 v[36:37], v55 offset:8192
  ds_read_b64_tr_b16 v[38:39], v55 offset:9216
  s_waitcnt lgkmcnt(6)
  v_mfma_f32_32x32x16_bf16 v[64:79], v[24:27], v[40:43], v[64:79]
  v_mfma_f32_32x32x16_bf16 v[80:95], v[24:27], v[44:47], v[80:95]
  v_mfma_f32_32x32x16_bf16 v[96:111], v[28:31], v[40:43], v[96:111]
  v_mfma_f32_32x32x16_bf16 v[112:127], v[28:31], v[44:47], v[112:127]
  ds_read_b128 v[24:27], v139 offset:0
  ds_read_b128 v[28:31], v139 offset:4096
  ds_read_b64_tr_b16 v[40:41], v54 offset:12288
  ds_read_b64_tr_b16 v[42:43], v54 offset:13312
  ds_read_b64_tr_b16 v[44:45], v55 offset:12288
  ds_read_b64_tr_b16 v[46:47], v55 offset:13312
  s_waitcnt lgkmcnt(6)
  v_mfma_f32_32x32x16_bf16 v[64:79], v[16:19], v[32:35], v[64:79]
  v_mfma_f32_32x32x16_bf16 v[80:95], v[16:19], v[36:39], v[80:95]
  v_mfma_f32_32x32x16_bf16 v[96:111], v[20:23], v[32:35], v[96:111]
  v_mfma_f32_32x32x16_bf16 v[112:127], v[20:23], v[36:39], v[112:127]
  s_barrier
  ds_read_b128 v[16:19], v140 offset:0
  ds_read_b128 v[20:23], v140 offset:4096
  ds_read_b64_tr_b16 v[32:33], v54 offset:16384
  ds_read_b64_tr_b16 v[34:35], v54 offset:17408
  ds_read_b64_tr_b16 v[36:37], v55 offset:16384
  ds_read_b64_tr_b16 v[38:39], v55 offset:17408
  s_waitcnt lgkmcnt(6)
  v_mfma_f32_32x32x16_bf16 v[64:79], v[24:27], v[40:43], v[64:79]
  v_mfma_f32_32x32x16_bf16 v[80:95], v[24:27], v[44:47], v[80:95]
  v_mfma_f32_32x32x16_bf16 v[96:111], v[28:31], v[40:43], v[96:111]
  v_mfma_f32_32x32x16_bf16 v[112:127], v[28:31], v[44:47], v[112:127]
  ds_read_b128 v[24:27], v141 offset:0
  ds_read_b128 v[28:31], v141 offset:4096
  ds_read_b64_tr_b16 v[40:41], v54 offset:20480
  ds_read_b64_tr_b16 v[42:43], v54 offset:21504
  ds_read_b64_tr_b16 v[44:45], v55 offset:20480
  ds_read_b64_tr_b16 v[46:47], v55 offset:21504
  s_waitcnt lgkmcnt(6)
  v_mfma_f32_32x32x16_bf16 v[64:79], v[16:19], v[32:35], v[64:79]
  v_mfma_f32_32x32x16_bf16 v[80:95], v[16:19], v[36:39], v[80:95]
  v_mfma_f32_32x32x16_bf16 v[96:111], v[20:23], v[32:35], v[96:111]
  v_mfma_f32_32x32x16_bf16 v[112:127], v[20:23], v[36:39], v[112:127]
  s_barrier
  ds_read_b128 v[16:19], v142 offset:0
  ds_read_b128 v[20:23], v142 offset:4096
  ds_read_b64_tr_b16 v[32:33], v54 offset:24576
  ds_read_b64_tr_b16 v[34:35], v54 offset:25600
  ds_read_b64_tr_b16 v[36:37], v55 offset:24576
  ds_read_b64_tr_b16 v[38:39], v55 offset:25600
  s_waitcnt lgkmcnt(6)
  v_mfma_f32_32x32x16_bf16 v[64:79], v[24:27], v[40:43], v[64:79]
  v_mfma_f32_32x32x16_bf16 v[80:95], v[24:27], v[44:47], v[80:95]
  v_mfma_f32_32x32x16_bf16 v[96:111], v[28:31], v[40:43], v[96:111]
  v_mfma_f32_32x32x16_bf16 v[112:127], v[28:31], v[44:47], v[112:127]
  ds_read_b128 v[24:27], v143 offset:0
  ds_read_b128 v[28:31], v143 offset:4096
  ds_read_b64_tr_b16 v[40:41], v54 offset:28672
  ds_read_b64_tr_b16 v[42:43], v54 offset:29696
  ds_read_b64_tr_b16 v[44:45], v55 offset:28672
  ds_read_b64_tr_b16 v[46:47], v55 offset:29696
  s_waitcnt lgkmcnt(6)
  v_mfma_f32_32x32x16_bf16 v[64:79], v[16:19], v[32:35], v[64:79]
  v_mfma_f32_32x32x16_bf16 v[80:95], v[16:19], v[36:39], v[80:95]
  v_mfma_f32_32x32x16_bf16 v[96:111], v[20:23], v[32:35], v[96:111]
  v_mfma_f32_32x32x16_bf16 v[112:127], v[20:23], v[36:39], v[112:127]
  s_barrier
  ds_read_b128 v[16:19], v128 offset:0
  ds_read_b128 v[20:23], v128 offset:4096
  ds_read_b64_tr_b16 v[32:33], v54 offset:0
  ds_read_b64_tr_b16 v[34:35], v54 offset:1024
  ds_read_b64_tr_b16 v[36:37], v55 offset:0
  ds_read_b64_tr_b16 v[38:39], v55 offset:1024
  s_waitcnt lgkmcnt(6)
  v_mfma_f32_32x32x16_bf16 v[64:79], v[24:27], v[40:43], v[64:79]
  v_mfma_f32_32x32x16_bf16 v[80:95], v[24:27], v[44:47], v[80:95]
  v_mfma_f32_32x32x16_bf16 v[96:111], v[28:31], v[40:43], v[96:111]
  v_mfma_f32_32x32x16_bf16 v[112:127], v[28:31], v[44:47], v[112:127]
  ds_read_b128 v[24:27], v129 offset:0
  ds_read_b128 v[28:31], v129 offset:4096
  ds_read_b64_tr_b16 v[40:41], v54 offset:4096
  ds_read_b64_tr_b16 v[42:43], v54 offset:5120
  ds_read_b64_tr_b16 v[44:45], v55 offset:4096
  ds_read_b64_tr_b16 v[46:47], v55 offset:5120
  s_waitcnt lgkmcnt(6)
  v_mfma_f32_32x32x16_bf16 v[64:79], v[16:19], v[32:35], v[64:79]
  v_mfma_f32_32x32x16_bf16 v[80:95], v[16:19], v[36:39], v[80:95]
  v_mfma_f32_32x32x16_bf16 v[96:111], v[20:23], v[32:35], v[96:111]
  v_mfma_f32_32x32x16_bf16 v[112:127], v[20:23], v[36:39], v[112:127]
  s_barrier
  ds_read_b128 v[16:19], v130 offset:0
  ds_read_b128 v[20:23], v130 offset:4096
  ds_read_b64_tr_b16 v[32:33], v54 offset:8192
  ds_read_b64_tr_b16 v[34:35], v54 offset:9216
  ds_read_b64_tr_b16 v[36:37], v55 offset:8192
  ds_read_b64_tr_b16 v[38:39], v55 offset:9216
  s_waitcnt lgkmcnt(6)
  v_mfma_f32_32x32x16_bf16 v[64:79], v[24:27], v[40:43], v[64:79]
  v_mfma_f32_32x32x16_bf16 v[80:95], v[24:27], v[44:47], v[80:95]
  v_mfma_f32_32x32x16_bf16 v[96:111], v[28:31], v[40:43], v[96:111]
  v_mfma_f32_32x32x16_bf16 v[112:127], v[28:31], v[44:47], v[112:127]
  ds_read_b128 v[24:27], v131 offset:0
  ds_read_b128 v[28:31], v131 offset:4096
  ds_read_b64_tr_b16 v[40:41], v54 offset:12288
  ds_read_b64_tr_b16 v[42:43], v54 offset:13312
  ds_read_b64_tr_b16 v[44:45], v55 offset:12288
  ds_read_b64_tr_b16 v[46:47], v55 offset:13312
  s_waitcnt lgkmcnt(6)
  v_mfma_f32_32x32x16_bf16 v[64:79], v[16:19], v[32:35], v[64:79]
  v_mfma_f32_32x32x16_bf16 v[80:95], v[16:19], v[36:39], v[80:95]
  v_mfma_f32_32x32x16_bf16 v[96:111], v[20:23], v[32:35], v[96:111]
  v_mfma_f32_32x32x16_bf16 v[112:127], v[20:23], v[36:39], v[112:127]
  s_barrier
  ds_read_b128 v[16:19], v132 offset:0
  ds_read_b128 v[20:23], v132 offset:4096
  ds_read_b64_tr_b16 v[32:33], v54 offset:16384
  ds_read_b64_tr_b16 v[34:35], v54 offset:17408
  ds_read_b64_tr_b16 v[36:37], v55 offset:16384
  ds_read_b64_tr_b16 v[38:39], v55 offset:17408
  s_waitcnt lgkmcnt(6)
  v_mfma_f32_32x32x16_bf16 v[64:79], v[24:27], v[40:43], v[64:79]
  v_mfma_f32_32x32x16_bf16 v[80:95], v[24:27], v[44:47], v[80:95]
  v_mfma_f32_32x32x16_bf16 v[96:111], v[28:31], v[40:43], v[96:111]
  v_mfma_f32_32x32x16_bf16 v[112:127], v[28:31], v[44:47], v[112:127]
  ds_read_b128 v[24:27], v133 offset:0
  ds_read_b128 v[28:31], v133 offset:4096
  ds_read_b64_tr_b16 v[40:41], v54 offset:20480
  ds_read_b64_tr_b16 v[42:43], v54 offset:21504
  ds_read_b64_tr_b16 v[44:45], v55 offset:20480
  ds_read_b64_tr_b16 v[46:47], v55 offset:21504
  s_waitcnt lgkmcnt(6)
  v_mfma_f32_32x32x16_bf16 v[64:79], v[16:19], v[32:35], v[64:79]
  v_mfma_f32_32x32x16_bf16 v[80:95], v[16:19], v[36:39], v[80:95]
  v_mfma_f32_32x32x16_bf16 v[96:111], v[20:23], v[32:35], v[96:111]
  v_mfma_f32_32x32x16_bf16 v[112:127], v[20:23], v[36:39], v[112:127]
  s_barrier
  ds_read_b128 v[16:19], v134 offset:0
  ds_read_b128 v[20:23], v134 offset:4096
  ds_read_b64_tr_b16 v[32:33], v54 offset:24576
  ds_read_b64_tr_b16 v[34:35], v54 offset:25600
  ds_read_b64_tr_b16 v[36:37], v55 offset:24576
  ds_read_b64_tr_b16 v[38:39], v55 offset:25600
  s_waitcnt lgkmcnt(6)
  v_mfma_f32_32x32x16_bf16 v[64:79], v[24:27], v[40:43], v[64:79]
  v_mfma_f32_32x32x16_bf16 v[80:95], v[24:27], v[44:47], v[80:95]
  v_mfma_f32_32x32x16_bf16 v[96:111], v[28:31], v[40:43], v[96:111]
  v_mfma_f32_32x32x16_bf16 v[112:127], v[28:31], v[44:47], v[112:127]
  ds_read_b128 v[24:27], v135 offset:0
  ds_read_b128 v[28:31], v135 offset:4096
  ds_read_b64_tr_b16 v[40:41], v54 offset:28672
  ds_read_b64_tr_b16 v[42:43], v54 offset:29696
  ds_read_b64_tr_b16 v[44:45], v55 offset:28672
  ds_read_b64_tr_b16 v[46:47], v55 offset:29696
  s_waitcnt lgkmcnt(6)
  v_mfma_f32_32x32x16_bf16 v[64:79], v[16:19], v[32:35], v[64:79]
  v_mfma_f32_32x32x16_bf16 v[80:95], v[16:19], v[36:39], v[80:95]
  v_mfma_f32_32x32x16_bf16 v[96:111], v[20:23], v[32:35], v[96:111]
  v_mfma_f32_32x32x16_bf16 v[112:127], v[20:23], v[36:39], v[112:127]
  s_barrier
  ds_read_b128 v[16:19], v136 offset:0
  ds_read_b128 v[20:23], v136 offset:4096
  ds_read_b64_tr_b16 v[32:33], v54 offset:0
  ds_read_b64_tr_b16 v[34:35], v54 offset:1024
  ds_read_b64_tr_b16 v[36:37], v55 offset:0
  ds_read_b64_tr_b16 v[38:39], v55 offset:1024
  s_waitcnt lgkmcnt(6)
  v_mfma_f32_32x32x16_bf16 v[64:79], v[24:27], v[40:43], v[64:79]
  v_mfma_f32_32x32x16_bf16 v[80:95], v[24:27], v[44:47], v[80:95]
  v_mfma_f32_32x32x16_bf16 v[96:111], v[28:31], v[40:43], v[96:111]
  v_mfma_f32_32x32x16_bf16 v[112:127], v[28:31], v[44:47], v[112:127]
  ds_read_b128 v[24:27], v137 offset:0
  ds_read_b128 v[28:31], v137 offset:4096
  ds_read_b64_tr_b16 v[40:41], v54 offset:4096
  ds_read_b64_tr_b16 v[42:43], v54 offset:5120
  ds_read_b64_tr_b16 v[44:45], v55 offset:4096
  ds_read_b64_tr_b16 v[46:47], v55 offset:5120
  s_waitcnt lgkmcnt(6)
  v_mfma_f32_32x32x16_bf16 v[64:79], v[16:19], v[32:35], v[64:79]
  v_mfma_f32_32x32x16_bf16 v[80:95], v[16:19], v[36:39], v[80:95]
  v_mfma_f32_32x32x16_bf16 v[96:111], v[20:23], v[32:35], v[96:111]
  v_mfma_f32_32x32x16_bf16 v[112:127], v[20:23], v[36:39], v[112:127]
  s_barrier
  ds_read_b128 v[16:19], v138 offset:0
  ds_read_b128 v[20:23], v138 offset:4096
  ds_read_b64_tr_b16 v[32:33], v54 offset:8192
  ds_read_b64_tr_b16 v[34:35], v54 offset:9216
  ds_read_b64_tr_b16 v[36:37], v55 offset:8192
  ds_read_b64_tr_b16 v[38:39], v55 offset:9216
  s_waitcnt lgkmcnt(6)
  v_mfma_f32_32x32x16_bf16 v[64:79], v[24:27], v[40:43], v[64:79]
  v_mfma_f32_32x32x16_bf16 v[80:95], v[24:27], v[44:47], v[80:95]
  v_mfma_f32_32x32x16_bf16 v[96:111], v[28:31], v[40:43], v[96:111]
  v_mfma_f32_32x32x16_bf16 v[112:127], v[28:31], v[44:47], v[112:127]
  ds_read_b128 v[24:27], v139 offset:0
  ds_read_b128 v[28:31], v139 offset:4096
  ds_read_b64_tr_b16 v[40:41], v54 offset:12288
  ds_read_b64_tr_b16 v[42:43], v54 offset:13312
  ds_read_b64_tr_b16 v[44:45], v55 offset:12288
  ds_read_b64_tr_b16 v[46:47], v55 offset:13312
  s_waitcnt lgkmcnt(6)
  v_mfma_f32_32x32x16_bf16 v[64:79], v[16:19], v[32:35], v[64:79]
  v_mfma_f32_32x32x16_bf16 v[80:95], v[16:19], v[36:39], v[80:95]
  v_mfma_f32_32x32x16_bf16 v[96:111], v[20:23], v[32:35], v[96:111]
  v_mfma_f32_32x32x16_bf16 v[112:127], v[20:23], v[36:39], v[112:127]
  s_barrier
  ds_read_b128 v[16:19], v140 offset:0
  ds_read_b128 v[20:23], v140 offset:4096
  ds_read_b64_tr_b16 v[32:33], v54 offset:16384
  ds_read_b64_tr_b16 v[34:35], v54 offset:17408
  ds_read_b64_tr_b16 v[36:37], v55 offset:16384
  ds_read_b64_tr_b16 v[38:39], v55 offset:17408
  s_waitcnt lgkmcnt(6)
  v_mfma_f32_32x32x16_bf16 v[64:79], v[24:27], v[40:43], v[64:79]
  v_mfma_f32_32x32x16_bf16 v[80:95], v[24:27], v[44:47], v[80:95]
  v_mfma_f32_32x32x16_bf16 v[96:111], v[28:31], v[40:43], v[96:111]
  v_mfma_f32_32x32x16_bf16 v[112:127], v[28:31], v[44:47], v[112:127]
  ds_read_b128 v[24:27], v141 offset:0
  ds_read_b128 v[28:31], v141 offset:4096
  ds_read_b64_tr_b16 v[40:41], v54 offset:20480
  ds_read_b64_tr_b16 v[42:43], v54 offset:21504
  ds_read_b64_tr_b16 v[44:45], v55 offset:20480
  ds_read_b64_tr_b16 v[46:47], v55 offset:21504
  s_waitcnt lgkmcnt(6)
  v_mfma_f32_32x32x16_bf16 v[64:79], v[16:19], v[32:35], v[64:79]
  v_mfma_f32_32x32x16_bf16 v[80:95], v[16:19], v[36:39], v[80:95]
  v_mfma_f32_32x32x16_bf16 v[96:111], v[20:23], v[32:35], v[96:111]
  v_mfma_f32_32x32x16_bf16 v[112:127], v[20:23], v[36:39], v[112:127]
  s_barrier
  ds_read_b128 v[16:19], v142 offset:0
  ds_read_b128 v[20:23], v142 offset:4096
  ds_read_b64_tr_b16 v[32:33], v54 offset:24576
  ds_read_b64_tr_b16 v[34:35], v54 offset:25600
  ds_read_b64_tr_b16 v[36:37], v55 offset:24576
  ds_read_b64_tr_b16 v[38:39], v55 offset:25600
  s_waitcnt lgkmcnt(6)
  v_mfma_f32_32x32x16_bf16 v[64:79], v[24:27], v[40:43], v[64:79]
  v_mfma_f32_32x32x16_bf16 v[80:95], v[24:27], v[44:47], v[80:95]
  v_mfma_f32_32x32x16_bf16 v[96:111], v[28:31], v[40:43], v[96:111]
  v_mfma_f32_32x32x16_bf16 v[112:127], v[28:31], v[44:47], v[112:127]
  ds_read_b128 v[24:27], v143 offset:0
  ds_read_b128 v[28:31], v143 offset:4096
  ds_read_b64_tr_b16 v[40:41], v54 offset:28672
  ds_read_b64_tr_b16 v[42:43], v54 offset:29696
  ds_read_b64_tr_b16 v[44:45], v55 offset:28672
  ds_read_b64_tr_b16 v[46:47], v55 offset:29696
  s_waitcnt lgkmcnt(6)
  v_mfma_f32_32x32x16_bf16 v[64:79], v[16:19], v[32:35], v[64:79]
  v_mfma_f32_32x32x16_bf16 v[80:95], v[16:19], v[36:39], v[80:95]
  v_mfma_f32_32x32x16_bf16 v[96:111], v[20:23], v[32:35], v[96:111]
  v_mfma_f32_32x32x16_bf16 v[112:127], v[20:23], v[36:39], v[112:127]
  s_barrier
  ds_read_b128 v[16:19], v128 offset:0
  ds_read_b128 v[20:23], v128 offset:4096
  ds_read_b64_tr_b16 v[32:33], v54 offset:0
  ds_read_b64_tr_b16 v[34:35], v54 offset:1024
  ds_read_b64_tr_b16 v[36:37], v55 offset:0
  ds_read_b64_tr_b16 v[38:39], v55 offset:1024
  s_waitcnt lgkmcnt(6)
  v_mfma_f32_32x32x16_bf16 v[64:79], v[24:27], v[40:43], v[64:79]
  v_mfma_f32_32x32x16_bf16 v[80:95], v[24:27], v[44:47], v[80:95]
  v_mfma_f32_32x32x16_bf16 v[96:111], v[28:31], v[40:43], v[96:111]
  v_mfma_f32_32x32x16_bf16 v[112:127], v[28:31], v[44:47], v[112:127]
  ds_read_b128 v[24:27], v129 offset:0
  ds_read_b128 v[28:31], v129 offset:4096
  ds_read_b64_tr_b16 v[40:41], v54 offset:4096
  ds_read_b64_tr_b16 v[42:43], v54 offset:5120
  ds_read_b64_tr_b16 v[44:45], v55 offset:4096
  ds_read_b64_tr_b16 v[46:47], v55 offset:5120
  s_waitcnt lgkmcnt(6)
  v_mfma_f32_32x32x16_bf16 v[64:79], v[16:19], v[32:35], v[64:79]
  v_mfma_f32_32x32x16_bf16 v[80:95], v[16:19], v[36:39], v[80:95]
  v_mfma_f32_32x32x16_bf16 v[96:111], v[20:23], v[32:35], v[96:111]
  v_mfma_f32_32x32x16_bf16 v[112:127], v[20:23], v[36:39], v[112:127]
  s_barrier
  ds_read_b128 v[16:19], v130 offset:0
  ds_read_b128 v[20:23], v130 offset:4096
  ds_read_b64_tr_b16 v[32:33], v54 offset:8192
  ds_read_b64_tr_b16 v[34:35], v54 offset:9216
  ds_read_b64_tr_b16 v[36:37], v55 offset:8192
  ds_read_b64_tr_b16 v[38:39], v55 offset:9216
  s_waitcnt lgkmcnt(6)
  v_mfma_f32_32x32x16_bf16 v[64:79], v[24:27], v[40:43], v[64:79]
  v_mfma_f32_32x32x16_bf16 v[80:95], v[24:27], v[44:47], v[80:95]
  v_mfma_f32_32x32x16_bf16 v[96:111], v[28:31], v[40:43], v[96:111]
  v_mfma_f32_32x32x16_bf16 v[112:127], v[28:31], v[44:47], v[112:127]
  ds_read_b128 v[24:27], v131 offset:0
  ds_read_b128 v[28:31], v131 offset:4096
  ds_read_b64_tr_b16 v[40:41], v54 offset:12288
  ds_read_b64_tr_b16 v[42:43], v54 offset:13312
  ds_read_b64_tr_b16 v[44:45], v55 offset:12288
  ds_read_b64_tr_b16 v[46:47], v55 offset:13312
  s_waitcnt lgkmcnt(6)
  v_mfma_f32_32x32x16_bf16 v[64:79], v[16:19], v[32:35], v[64:79]
  v_mfma_f32_32x32x16_bf16 v[80:95], v[16:19], v[36:39], v[80:95]
  v_mfma_f32_32x32x16_bf16 v[96:111], v[20:23], v[32:35], v[96:111]
  v_mfma_f32_32x32x16_bf16 v[112:127], v[20:23], v[36:39], v[112:127]
  s_barrier
  ds_read_b128 v[16:19], v132 offset:0
  ds_read_b128 v[20:23], v132 offset:4096
  ds_read_b64_tr_b16 v[32:33], v54 offset:16384
  ds_read_b64_tr_b16 v[34:35], v54 offset:17408
  ds_read_b64_tr_b16 v[36:37], v55 offset:16384
  ds_read_b64_tr_b16 v[38:39], v55 offset:17408
  s_waitcnt lgkmcnt(6)
  v_mfma_f32_32x32x16_bf16 v[64:79], v[24:27], v[40:43], v[64:79]
  v_mfma_f32_32x32x16_bf16 v[80:95], v[24:27], v[44:47], v[80:95]
  v_mfma_f32_32x32x16_bf16 v[96:111], v[28:31], v[40:43], v[96:111]
  v_mfma_f32_32x32x16_bf16 v[112:127], v[28:31], v[44:47], v[112:127]
  ds_read_b128 v[24:27], v133 offset:0
  ds_read_b128 v[28:31], v133 offset:4096
  ds_read_b64_tr_b16 v[40:41], v54 offset:20480
  ds_read_b64_tr_b16 v[42:43], v54 offset:21504
  ds_read_b64_tr_b16 v[44:45], v55 offset:20480
  ds_read_b64_tr_b16 v[46:47], v55 offset:21504
  s_waitcnt lgkmcnt(6)
  v_mfma_f32_32x32x16_bf16 v[64:79], v[16:19], v[32:35], v[64:79]
  v_mfma_f32_32x32x16_bf16 v[80:95], v[16:19], v[36:39], v[80:95]
  v_mfma_f32_32x32x16_bf16 v[96:111], v[20:23], v[32:35], v[96:111]
  v_mfma_f32_32x32x16_bf16 v[112:127], v[20:23], v[36:39], v[112:127]
  s_barrier
  ds_read_b128 v[16:19], v134 offset:0
  ds_read_b128 v[20:23], v134 offset:4096
  ds_read_b64_tr_b16 v[32:33], v54 offset:24576
  ds_read_b64_tr_b16 v[34:35], v54 offset:25600
  ds_read_b64_tr_b16 v[36:37], v55 offset:24576
  ds_read_b64_tr_b16 v[38:39], v55 offset:25600
  s_waitcnt lgkmcnt(6)
  v_mfma_f32_32x32x16_bf16 v[64:79], v[24:27], v[40:43], v[64:79]
  v_mfma_f32_32x32x16_bf16 v[80:95], v[24:27], v[44:47], v[80:95]
  v_mfma_f32_32x32x16_bf16 v[96:111], v[28:31], v[40:43], v[96:111]
  v_mfma_f32_32x32x16_bf16 v[112:127], v[28:31], v[44:47], v[112:127]
  ds_read_b128 v[24:27], v135 offset:0
  ds_read_b128 v[28:31], v135 offset:4096
  ds_read_b64_tr_b16 v[40:41], v54 offset:28672
  ds_read_b64_tr_b16 v[42:43], v54 offset:29696
  ds_read_b64_tr_b16 v[44:45], v55 offset:28672
  ds_read_b64_tr_b16 v[46:47], v55 offset:29696
  s_waitcnt lgkmcnt(6)
  v_mfma_f32_32x32x16_bf16 v[64:79], v[16:19], v[32:35], v[64:79]
  v_mfma_f32_32x32x16_bf16 v[80:95], v[16:19], v[36:39], v[80:95]
  v_mfma_f32_32x32x16_bf16 v[96:111], v[20:23], v[32:35], v[96:111]
  v_mfma_f32_32x32x16_bf16 v[112:127], v[20:23], v[36:39], v[112:127]
  s_waitcnt lgkmcnt(0)
  v_mfma_f32_32x32x16_bf16 v[64:79], v[24:27], v[40:43], v[64:79]
  v_mfma_f32_32x32x16_bf16 v[80:95], v[24:27], v[44:47], v[80:95]
  v_mfma_f32_32x32x16_bf16 v[96:111], v[28:31], v[40:43], v[96:111]
  v_mfma_f32_32x32x16_bf16 v[112:127], v[28:31], v[44:47], v[112:127]
  s_nop 11
  s_cmp_eq_u32 s9, 0
  s_mov_b32 s60, 19922944
  s_cselect_b32 s44, 3145728, s60
  s_lshl_b32 s48, s11, 3
  s_lshl_b32 s49, s13, 1
  s_add_u32 s48, s48, s49
  s_mul_i32 s48, s48, 3072
  s_add_u32 s44, s44, s48
  s_add_u32 s44, s44, 1536
  s_sub_u32 s46, s12, 10
  s_lshl_b32 s46, s46, 7
  s_lshl_b32 s48, s14, 6
  s_add_u32 s46, s46, s48
  v_and_b32 v4, 31, v1
  v_lshrrev_b32 v5, 5, v1
  v_mul_u32_u24 v5, 384, v5
  s_mov_b32 s50, 52429
  s_mov_b32 s51, 196608
  s_add_u32 s48, s46, 0
  v_add_u32 v6, s48, v4
  v_mul_u32_u24 v7, s50, v6
  v_lshrrev_b32 v7, 20, v7
  v_mul_u32_u24 v8, 20, v7
  v_sub_u32 v8, v6, v8
  v_mul_lo_u32 v7, v7, s51
  v_lshl_add_u32 v7, v8, 4, v7
  v_add_u32 v7, v7, v5
  v_cmp_lt_u32 s[60:61], 15, v8
  v_cmp_eq_u32 vcc, 16, v8
  v_mov_b32 v9, 0x3f803f80
  s_nop 0
  v_cndmask_b32 v32, 0, v9, vcc
  v_cndmask_b32 v33, 0, v9, vcc
  v_cndmask_b32 v34, 0, v9, vcc
  v_cndmask_b32 v35, 0, v9, vcc
  v_cvt_pk_bf16_f32 v16, v64, v65
  v_cvt_pk_bf16_f32 v17, v66, v67
  v_cvt_pk_bf16_f32 v18, v68, v69
  v_cvt_pk_bf16_f32 v19, v70, v71
  s_add_u32 s57, s44, 0
  buffer_store_dwordx4 v[16:19], v7, s[4:7], s57 offen
  s_mov_b64 exec, s[60:61]
  buffer_store_dwordx4 v[32:35], v7, s[4:7], s57 offen offset:64
  s_mov_b64 exec, -1
  v_cvt_pk_bf16_f32 v20, v72, v73
  v_cvt_pk_bf16_f32 v21, v74, v75
  v_cvt_pk_bf16_f32 v22, v76, v77
  v_cvt_pk_bf16_f32 v23, v78, v79
  s_add_u32 s57, s44, 768
  buffer_store_dwordx4 v[20:23], v7, s[4:7], s57 offen
  s_mov_b64 exec, s[60:61]
  buffer_store_dwordx4 v[32:35], v7, s[4:7], s57 offen offset:64
  s_mov_b64 exec, -1
  v_cvt_pk_bf16_f32 v24, v96, v97
  v_cvt_pk_bf16_f32 v25, v98, v99
  v_cvt_pk_bf16_f32 v26, v100, v101
  v_cvt_pk_bf16_f32 v27, v102, v103
  s_add_u32 s57, s44, 3072
  buffer_store_dwordx4 v[24:27], v7, s[4:7], s57 offen
  s_mov_b64 exec, s[60:61]
  buffer_store_dwordx4 v[32:35], v7, s[4:7], s57 offen offset:64
  s_mov_b64 exec, -1
  v_cvt_pk_bf16_f32 v28, v104, v105
  v_cvt_pk_bf16_f32 v29, v106, v107
  v_cvt_pk_bf16_f32 v30, v108, v109
  v_cvt_pk_bf16_f32 v31, v110, v111
  s_add_u32 s57, s44, 3840
  buffer_store_dwordx4 v[28:31], v7, s[4:7], s57 offen
  s_mov_b64 exec, s[60:61]
  buffer_store_dwordx4 v[32:35], v7, s[4:7], s57 offen offset:64
  s_mov_b64 exec, -1
  s_add_u32 s48, s46, 32
  v_add_u32 v6, s48, v4
  v_mul_u32_u24 v7, s50, v6
  v_lshrrev_b32 v7, 20, v7
  v_mul_u32_u24 v8, 20, v7
  v_sub_u32 v8, v6, v8
  v_mul_lo_u32 v7, v7, s51
  v_lshl_add_u32 v7, v8, 4, v7
  v_add_u32 v7, v7, v5
  v_cmp_lt_u32 s[60:61], 15, v8
  v_cmp_eq_u32 vcc, 16, v8
  v_mov_b32 v9, 0x3f803f80
  s_nop 0
  v_cndmask_b32 v32, 0, v9, vcc
  v_cndmask_b32 v33, 0, v9, vcc
  v_cndmask_b32 v34, 0, v9, vcc
  v_cndmask_b32 v35, 0, v9, vcc
  v_cvt_pk_bf16_f32 v16, v80, v81
  v_cvt_pk_bf16_f32 v17, v82, v83
  v_cvt_pk_bf16_f32 v18, v84, v85
  v_cvt_pk_bf16_f32 v19, v86, v87
  s_add_u32 s57, s44, 0
  buffer_store_dwordx4 v[16:19], v7, s[4:7], s57 offen
  s_mov_b64 exec, s[60:61]
  buffer_store_dwordx4 v[32:35], v7, s[4:7], s57 offen offset:64
  s_mov_b64 exec, -1
  v_cvt_pk_bf16_f32 v20, v88, v89
  v_cvt_pk_bf16_f32 v21, v90, v91
  v_cvt_pk_bf16_f32 v22, v92, v93
  v_cvt_pk_bf16_f32 v23, v94, v95
  s_add_u32 s57, s44, 768
  buffer_store_dwordx4 v[20:23], v7, s[4:7], s57 offen
  s_mov_b64 exec, s[60:61]
  buffer_store_dwordx4 v[32:35], v7, s[4:7], s57 offen offset:64
  s_mov_b64 exec, -1
  v_cvt_pk_bf16_f32 v24, v112, v113
  v_cvt_pk_bf16_f32 v25, v114, v115
  v_cvt_pk_bf16_f32 v26, v116, v117
  v_cvt_pk_bf16_f32 v27, v118, v119
  s_add_u32 s57, s44, 3072
  buffer_store_dwordx4 v[24:27], v7, s[4:7], s57 offen
  s_mov_b64 exec, s[60:61]
  buffer_store_dwordx4 v[32:35], v7, s[4:7], s57 offen offset:64
  s_mov_b64 exec, -1
  v_cvt_pk_bf16_f32 v28, v120, v121
  v_cvt_pk_bf16_f32 v29, v122, v123
  v_cvt_pk_bf16_f32 v30, v124, v125
  v_cvt_pk_bf16_f32 v31, v126, v127
  s_add_u32 s57, s44, 3840
  buffer_store_dwordx4 v[28:31], v7, s[4:7], s57 offen
  s_mov_b64 exec, s[60:61]
  buffer_store_dwordx4 v[32:35], v7, s[4:7], s57 offen offset:64
  s_mov_b64 exec, -1
  s_branch L_proj_kernel_end
L_proj_kernel_aux:
  s_nop 4
  s_cmp_lt_u32 s8, 4
  s_cbranch_scc1 L_proj_kernel_aux2
  s_barrier
  s_branch L_proj_kernel_exit
L_proj_kernel_aux2:
  s_lshr_b32 s9, s62, 1
  s_lshl_b32 s9, s9, 2
  s_add_u32 s9, s9, s63
  s_sub_u32 s9, s9, 28
  s_waitcnt lgkmcnt(0)
  s_load_dwordx2 s[24:25], s[0:1], 56
  s_load_dwordx2 s[26:27], s[0:1], 16
  s_load_dwordx2 s[36:37], s[0:1], 48
  s_waitcnt lgkmcnt(0)
  s_mov_b32 s6, 0x10000000
  s_mov_b32 s7, 0x00020000
  s_mov_b32 s28, s20
  s_mov_b32 s29, s21
  s_mov_b32 s30, 2621440
  s_mov_b32 s31, 0x00020000
  s_mov_b32 s32, s24
  s_mov_b32 s33, s25
  s_mov_b32 s34, 1280
  s_mov_b32 s35, 0x00020000
  s_mov_b32 s40, s26
  s_mov_b32 s41, s27
  s_mov_b32 s42, 819200
  s_mov_b32 s43, 0x00020000
  s_mov_b32 s44, s36
  s_mov_b32 s45, s37
  s_mov_b32 s46, 819200
  s_mov_b32 s47, 0x00020000
  s_or_b32 s10, s9, s8
  s_cmp_lg_u32 s10, 0
  s_cbranch_scc1 L_proj_kernel_nz
  v_lshlrev_b32 v5, 4, v1
  v_mov_b32 v16, 0
  v_mov_b32 v17, 0
  v_mov_b32 v18, 0
  v_mov_b32 v19, 0
  s_mov_b32 s10, 28311552
  buffer_store_dwordx4 v[16:19], v5, s[4:7], s10 offen offset:0
  buffer_store_dwordx4 v[16:19], v5, s[4:7], s10 offen offset:1024
  buffer_store_dwordx4 v[16:19], v5, s[4:7], s10 offen offset:2048
  buffer_store_dwordx4 v[16:19], v5, s[4:7], s10 offen offset:3072
L_proj_kernel_nz:
  s_nop 1
  v_lshlrev_b32 v5, 4, v1
  s_mul_i32 s17, s8, 10240
  v_add_u32 v6, s17, v5
  s_mul_i32 s18, s9, 40960
  s_add_u32 m0, s17, 0
  s_add_u32 s19, s18, 0
  buffer_load_dwordx4 v6, s[40:43], s19 offen offset:0 lds
  buffer_load_dwordx4 v6, s[40:43], s19 offen offset:1024 lds
  buffer_load_dwordx4 v6, s[40:43], s19 offen offset:2048 lds
  buffer_load_dwordx4 v6, s[40:43], s19 offen offset:3072 lds
  s_add_u32 m0, s17, 4096
  s_add_u32 s19, s18, 4096
  buffer_load_dwordx4 v6, s[40:43], s19 offen offset:0 lds
  buffer_load_dwordx4 v6, s[40:43], s19 offen offset:1024 lds
  buffer_load_dwordx4 v6, s[40:43], s19 offen offset:2048 lds
  buffer_load_dwordx4 v6, s[40:43], s19 offen offset:3072 lds
  s_add_u32 m0, s17, 8192
  s_add_u32 s19, s18, 8192
  buffer_load_dwordx4 v6, s[40:43], s19 offen offset:0 lds
  buffer_load_dwordx4 v6, s[40:43], s19 offen offset:1024 lds
  s_cmp_lt_u32 s9, 4
  s_cbranch_scc1 L_proj_kernel_s1a
  s_sub_u32 s18, s9, 4
  s_mul_i32 s18, s18, 40960
  s_add_u32 m0, s17, 40960
  s_add_u32 s19, s18, 0
  buffer_load_dwordx4 v6, s[44:47], s19 offen offset:0 lds
  buffer_load_dwordx4 v6, s[44:47], s19 offen offset:1024 lds
  buffer_load_dwordx4 v6, s[44:47], s19 offen offset:2048 lds
  buffer_load_dwordx4 v6, s[44:47], s19 offen offset:3072 lds
  s_add_u32 m0, s17, 45056
  s_add_u32 s19, s18, 4096
  buffer_load_dwordx4 v6, s[44:47], s19 offen offset:0 lds
  buffer_load_dwordx4 v6, s[44:47], s19 offen offset:1024 lds
  buffer_load_dwordx4 v6, s[44:47], s19 offen offset:2048 lds
  buffer_load_dwordx4 v6, s[44:47], s19 offen offset:3072 lds
  s_add_u32 m0, s17, 49152
  s_add_u32 s19, s18, 8192
  buffer_load_dwordx4 v6, s[44:47], s19 offen offset:0 lds
  buffer_load_dwordx4 v6, s[44:47], s19 offen offset:1024 lds
  s_branch L_proj_kernel_s1d
L_proj_kernel_s1a:
  s_add_u32 s18, s9, 16
  s_mul_i32 s18, s18, 40960
  s_add_u32 m0, s17, 40960
  s_add_u32 s19, s18, 0
  buffer_load_dwordx4 v6, s[40:43], s19 offen offset:0 lds
  buffer_load_dwordx4 v6, s[40:43], s19 offen offset:1024 lds
  buffer_load_dwordx4 v6, s[40:43], s19 offen offset:2048 lds
  buffer_load_dwordx4 v6, s[40:43], s19 offen offset:3072 lds
  s_add_u32 m0, s17, 45056
  s_add_u32 s19, s18, 4096
  buffer_load_dwordx4 v6, s[40:43], s19 offen offset:0 lds
  buffer_load_dwordx4 v6, s[40:43], s19 offen offset:1024 lds
  buffer_load_dwordx4 v6, s[40:43], s19 offen offset:2048 lds
  buffer_load_dwordx4 v6, s[40:43], s19 offen offset:3072 lds
  s_add_u32 m0, s17, 49152
  s_add_u32 s19, s18, 8192
  buffer_load_dwordx4 v6, s[40:43], s19 offen offset:0 lds
  buffer_load_dwordx4 v6, s[40:43], s19 offen offset:1024 lds
L_proj_kernel_s1d:
  s_cmp_ge_u32 s9, 8
  s_cbranch_scc1 L_proj_kernel_s2d
  s_add_u32 s18, s9, 12
  s_mul_i32 s18, s18, 40960
  s_add_u32 m0, s17, 81920
  s_add_u32 s19, s18, 0
  buffer_load_dwordx4 v6, s[44:47], s19 offen offset:0 lds
  buffer_load_dwordx4 v6, s[44:47], s19 offen offset:1024 lds
  buffer_load_dwordx4 v6, s[44:47], s19 offen offset:2048 lds
  buffer_load_dwordx4 v6, s[44:47], s19 offen offset:3072 lds
  s_add_u32 m0, s17, 86016
  s_add_u32 s19, s18, 4096
  buffer_load_dwordx4 v6, s[44:47], s19 offen offset:0 lds
  buffer_load_dwordx4 v6, s[44:47], s19 offen offset:1024 lds
  buffer_load_dwordx4 v6, s[44:47], s19 offen offset:2048 lds
  buffer_load_dwordx4 v6, s[44:47], s19 offen offset:3072 lds
  s_add_u32 m0, s17, 90112
  s_add_u32 s19, s18, 8192
  buffer_load_dwordx4 v6, s[44:47], s19 offen offset:0 lds
  buffer_load_dwordx4 v6, s[44:47], s19 offen offset:1024 lds
L_proj_kernel_s2d:
  v_and_b32 v3, 3, v1
  v_mul_u32_u24 v165, 320, v3
  buffer_load_dwordx4 v[84:87], v165, s[32:35], 0 offen offset:0
  buffer_load_dwordx4 v[88:91], v165, s[32:35], 0 offen offset:16
  buffer_load_dwordx4 v[92:95], v165, s[32:35], 0 offen offset:32
  buffer_load_dwordx4 v[96:99], v165, s[32:35], 0 offen offset:48
  buffer_load_dwordx4 v[100:103], v165, s[32:35], 0 offen offset:64
  buffer_load_dwordx4 v[104:107], v165, s[32:35], 0 offen offset:80
  buffer_load_dwordx4 v[108:111], v165, s[32:35], 0 offen offset:96
  buffer_load_dwordx4 v[112:115], v165, s[32:35], 0 offen offset:112
  buffer_load_dwordx4 v[116:119], v165, s[32:35], 0 offen offset:128
  buffer_load_dwordx4 v[120:123], v165, s[32:35], 0 offen offset:144
  buffer_load_dwordx4 v[124:127], v165, s[32:35], 0 offen offset:160
  buffer_load_dwordx4 v[128:131], v165, s[32:35], 0 offen offset:176
  buffer_load_dwordx4 v[132:135], v165, s[32:35], 0 offen offset:192
  buffer_load_dwordx4 v[136:139], v165, s[32:35], 0 offen offset:208
  buffer_load_dwordx4 v[140:143], v165, s[32:35], 0 offen offset:224
  buffer_load_dwordx4 v[144:147], v165, s[32:35], 0 offen offset:240
  buffer_load_dwordx4 v[148:151], v165, s[32:35], 0 offen offset:256
  buffer_load_dwordx4 v[152:155], v165, s[32:35], 0 offen offset:272
  buffer_load_dwordx4 v[156:159], v165, s[32:35], 0 offen offset:288
  buffer_load_dwordx4 v[160:163], v165, s[32:35], 0 offen offset:304
  v_lshrrev_b32 v2, 2, v1
  s_lshl_b32 s10, s9, 7
  s_lshl_b32 s11, s8, 4
  s_add_u32 s10, s10, s11
  s_add_u32 s10, s10, 0
  v_add_u32 v2, s10, v2
  s_movk_i32 s11, 1280
  v_mul_lo_u32 v4, v2, s11
  v_add_u32 v164, v4, v165
  v_mov_b32 v166, 0
  buffer_load_dwordx4 v[4:7], v164, s[28:31], 0 offen offset:0
  buffer_load_dwordx4 v[8:11], v164, s[28:31], 0 offen offset:16
  buffer_load_dwordx4 v[12:15], v164, s[28:31], 0 offen offset:32
  buffer_load_dwordx4 v[16:19], v164, s[28:31], 0 offen offset:48
  buffer_load_dwordx4 v[20:23], v164, s[28:31], 0 offen offset:64
  buffer_load_dwordx4 v[24:27], v164, s[28:31], 0 offen offset:80
  buffer_load_dwordx4 v[28:31], v164, s[28:31], 0 offen offset:96
  buffer_load_dwordx4 v[32:35], v164, s[28:31], 0 offen offset:112
  buffer_load_dwordx4 v[36:39], v164, s[28:31], 0 offen offset:128
  buffer_load_dwordx4 v[40:43], v164, s[28:31], 0 offen offset:144
  buffer_load_dwordx4 v[44:47], v164, s[28:31], 0 offen offset:160
  buffer_load_dwordx4 v[48:51], v164, s[28:31], 0 offen offset:176
  buffer_load_dwordx4 v[52:55], v164, s[28:31], 0 offen offset:192
  buffer_load_dwordx4 v[56:59], v164, s[28:31], 0 offen offset:208
  buffer_load_dwordx4 v[60:63], v164, s[28:31], 0 offen offset:224
  buffer_load_dwordx4 v[64:67], v164, s[28:31], 0 offen offset:240
  buffer_load_dwordx4 v[68:71], v164, s[28:31], 0 offen offset:256
  buffer_load_dwordx4 v[72:75], v164, s[28:31], 0 offen offset:272
  buffer_load_dwordx4 v[76:79], v164, s[28:31], 0 offen offset:288
  buffer_load_dwordx4 v[80:83], v164, s[28:31], 0 offen offset:304
  s_waitcnt vmcnt(0)
  v_dot2_f32_bf16 v166, v4, v84, v166
  v_dot2_f32_bf16 v166, v5, v85, v166
  v_dot2_f32_bf16 v166, v6, v86, v166
  v_dot2_f32_bf16 v166, v7, v87, v166
  v_dot2_f32_bf16 v166, v8, v88, v166
  v_dot2_f32_bf16 v166, v9, v89, v166
  v_dot2_f32_bf16 v166, v10, v90, v166
  v_dot2_f32_bf16 v166, v11, v91, v166
  v_dot2_f32_bf16 v166, v12, v92, v166
  v_dot2_f32_bf16 v166, v13, v93, v166
  v_dot2_f32_bf16 v166, v14, v94, v166
  v_dot2_f32_bf16 v166, v15, v95, v166
  v_dot2_f32_bf16 v166, v16, v96, v166
  v_dot2_f32_bf16 v166, v17, v97, v166
  v_dot2_f32_bf16 v166, v18, v98, v166
  v_dot2_f32_bf16 v166, v19, v99, v166
  v_dot2_f32_bf16 v166, v20, v100, v166
  v_dot2_f32_bf16 v166, v21, v101, v166
  v_dot2_f32_bf16 v166, v22, v102, v166
  v_dot2_f32_bf16 v166, v23, v103, v166
  v_dot2_f32_bf16 v166, v24, v104, v166
  v_dot2_f32_bf16 v166, v25, v105, v166
  v_dot2_f32_bf16 v166, v26, v106, v166
  v_dot2_f32_bf16 v166, v27, v107, v166
  v_dot2_f32_bf16 v166, v28, v108, v166
  v_dot2_f32_bf16 v166, v29, v109, v166
  v_dot2_f32_bf16 v166, v30, v110, v166
  v_dot2_f32_bf16 v166, v31, v111, v166
  v_dot2_f32_bf16 v166, v32, v112, v166
  v_dot2_f32_bf16 v166, v33, v113, v166
  v_dot2_f32_bf16 v166, v34, v114, v166
  v_dot2_f32_bf16 v166, v35, v115, v166
  v_dot2_f32_bf16 v166, v36, v116, v166
  v_dot2_f32_bf16 v166, v37, v117, v166
  v_dot2_f32_bf16 v166, v38, v118, v166
  v_dot2_f32_bf16 v166, v39, v119, v166
  v_dot2_f32_bf16 v166, v40, v120, v166
  v_dot2_f32_bf16 v166, v41, v121, v166
  v_dot2_f32_bf16 v166, v42, v122, v166
  v_dot2_f32_bf16 v166, v43, v123, v166
  v_dot2_f32_bf16 v166, v44, v124, v166
  v_dot2_f32_bf16 v166, v45, v125, v166
  v_dot2_f32_bf16 v166, v46, v126, v166
  v_dot2_f32_bf16 v166, v47, v127, v166
  v_dot2_f32_bf16 v166, v48, v128, v166
  v_dot2_f32_bf16 v166, v49, v129, v166
  v_dot2_f32_bf16 v166, v50, v130, v166
  v_dot2_f32_bf16 v166, v51, v131, v166
  v_dot2_f32_bf16 v166, v52, v132, v166
  v_dot2_f32_bf16 v166, v53, v133, v166
  v_dot2_f32_bf16 v166, v54, v134, v166
  v_dot2_f32_bf16 v166, v55, v135, v166
  v_dot2_f32_bf16 v166, v56, v136, v166
  v_dot2_f32_bf16 v166, v57, v137, v166
  v_dot2_f32_bf16 v166, v58, v138, v166
  v_dot2_f32_bf16 v166, v59, v139, v166
  v_dot2_f32_bf16 v166, v60, v140, v166
  v_dot2_f32_bf16 v166, v61, v141, v166
  v_dot2_f32_bf16 v166, v62, v142, v166
  v_dot2_f32_bf16 v166, v63, v143, v166
  v_dot2_f32_bf16 v166, v64, v144, v166
  v_dot2_f32_bf16 v166, v65, v145, v166
  v_dot2_f32_bf16 v166, v66, v146, v166
  v_dot2_f32_bf16 v166, v67, v147, v166
  v_dot2_f32_bf16 v166, v68, v148, v166
  v_dot2_f32_bf16 v166, v69, v149, v166
  v_dot2_f32_bf16 v166, v70, v150, v166
  v_dot2_f32_bf16 v166, v71, v151, v166
  v_dot2_f32_bf16 v166, v72, v152, v166
  v_dot2_f32_bf16 v166, v73, v153, v166
  v_dot2_f32_bf16 v166, v74, v154, v166
  v_dot2_f32_bf16 v166, v75, v155, v166
  v_dot2_f32_bf16 v166, v76, v156, v166
  v_dot2_f32_bf16 v166, v77, v157, v166
  v_dot2_f32_bf16 v166, v78, v158, v166
  v_dot2_f32_bf16 v166, v79, v159, v166
  v_dot2_f32_bf16 v166, v80, v160, v166
  v_dot2_f32_bf16 v166, v81, v161, v166
  v_dot2_f32_bf16 v166, v82, v162, v166
  v_dot2_f32_bf16 v166, v83, v163, v166
  s_nop 3
  v_add_f32_dpp v9, v166, v166 quad_perm:[1,0,3,2] row_mask:0xf bank_mask:0xf
  s_nop 1
  v_add_f32_dpp v8, v9, v9 quad_perm:[2,3,0,1] row_mask:0xf bank_mask:0xf
  v_mul_f32 v8, 0xbfb8aa3b, v8
  v_exp_f32 v8, v8
  s_nop 0
  v_add_f32 v8, 1.0, v8
  v_rcp_f32 v8, v8
  v_lshlrev_b32 v9, 2, v2
  s_mov_b32 s11, 9437184
  v_cmp_eq_u32 vcc, 0, v3
  s_nop 1
  s_and_saveexec_b64 s[12:13], vcc
  buffer_store_dword v8, v9, s[4:7], s11 offen
  s_mov_b64 exec, s[12:13]
  v_lshrrev_b32 v2, 2, v1
  s_lshl_b32 s10, s9, 7
  s_lshl_b32 s11, s8, 4
  s_add_u32 s10, s10, s11
  s_add_u32 s10, s10, 64
  v_add_u32 v2, s10, v2
  s_movk_i32 s11, 1280
  v_mul_lo_u32 v4, v2, s11
  v_add_u32 v164, v4, v165
  v_mov_b32 v166, 0
  buffer_load_dwordx4 v[4:7], v164, s[28:31], 0 offen offset:0
  buffer_load_dwordx4 v[8:11], v164, s[28:31], 0 offen offset:16
  buffer_load_dwordx4 v[12:15], v164, s[28:31], 0 offen offset:32
  buffer_load_dwordx4 v[16:19], v164, s[28:31], 0 offen offset:48
  buffer_load_dwordx4 v[20:23], v164, s[28:31], 0 offen offset:64
  buffer_load_dwordx4 v[24:27], v164, s[28:31], 0 offen offset:80
  buffer_load_dwordx4 v[28:31], v164, s[28:31], 0 offen offset:96
  buffer_load_dwordx4 v[32:35], v164, s[28:31], 0 offen offset:112
  buffer_load_dwordx4 v[36:39], v164, s[28:31], 0 offen offset:128
  buffer_load_dwordx4 v[40:43], v164, s[28:31], 0 offen offset:144
  buffer_load_dwordx4 v[44:47], v164, s[28:31], 0 offen offset:160
  buffer_load_dwordx4 v[48:51], v164, s[28:31], 0 offen offset:176
  buffer_load_dwordx4 v[52:55], v164, s[28:31], 0 offen offset:192
  buffer_load_dwordx4 v[56:59], v164, s[28:31], 0 offen offset:208
  buffer_load_dwordx4 v[60:63], v164, s[28:31], 0 offen offset:224
  buffer_load_dwordx4 v[64:67], v164, s[28:31], 0 offen offset:240
  buffer_load_dwordx4 v[68:71], v164, s[28:31], 0 offen offset:256
  buffer_load_dwordx4 v[72:75], v164, s[28:31], 0 offen offset:272
  buffer_load_dwordx4 v[76:79], v164, s[28:31], 0 offen offset:288
  buffer_load_dwordx4 v[80:83], v164, s[28:31], 0 offen offset:304
  s_waitcnt vmcnt(0)
  v_dot2_f32_bf16 v166, v4, v84, v166
  v_dot2_f32_bf16 v166, v5, v85, v166
  v_dot2_f32_bf16 v166, v6, v86, v166
  v_dot2_f32_bf16 v166, v7, v87, v166
  v_dot2_f32_bf16 v166, v8, v88, v166
  v_dot2_f32_bf16 v166, v9, v89, v166
  v_dot2_f32_bf16 v166, v10, v90, v166
  v_dot2_f32_bf16 v166, v11, v91, v166
  v_dot2_f32_bf16 v166, v12, v92, v166
  v_dot2_f32_bf16 v166, v13, v93, v166
  v_dot2_f32_bf16 v166, v14, v94, v166
  v_dot2_f32_bf16 v166, v15, v95, v166
  v_dot2_f32_bf16 v166, v16, v96, v166
  v_dot2_f32_bf16 v166, v17, v97, v166
  v_dot2_f32_bf16 v166, v18, v98, v166
  v_dot2_f32_bf16 v166, v19, v99, v166
  v_dot2_f32_bf16 v166, v20, v100, v166
  v_dot2_f32_bf16 v166, v21, v101, v166
  v_dot2_f32_bf16 v166, v22, v102, v166
  v_dot2_f32_bf16 v166, v23, v103, v166
  v_dot2_f32_bf16 v166, v24, v104, v166
  v_dot2_f32_bf16 v166, v25, v105, v166
  v_dot2_f32_bf16 v166, v26, v106, v166
  v_dot2_f32_bf16 v166, v27, v107, v166
  v_dot2_f32_bf16 v166, v28, v108, v166
  v_dot2_f32_bf16 v166, v29, v109, v166
  v_dot2_f32_bf16 v166, v30, v110, v166
  v_dot2_f32_bf16 v166, v31, v111, v166
  v_dot2_f32_bf16 v166, v32, v112, v166
  v_dot2_f32_bf16 v166, v33, v113, v166
  v_dot2_f32_bf16 v166, v34, v114, v166
  v_dot2_f32_bf16 v166, v35, v115, v166
  v_dot2_f32_bf16 v166, v36, v116, v166
  v_dot2_f32_bf16 v166, v37, v117, v166
  v_dot2_f32_bf16 v166, v38, v118, v166
  v_dot2_f32_bf16 v166, v39, v119, v166
  v_dot2_f32_bf16 v166, v40, v120, v166
  v_dot2_f32_bf16 v166, v41, v121, v166
  v_dot2_f32_bf16 v166, v42, v122, v166
  v_dot2_f32_bf16 v166, v43, v123, v166
  v_dot2_f32_bf16 v166, v44, v124, v166
  v_dot2_f32_bf16 v166, v45, v125, v166
  v_dot2_f32_bf16 v166, v46, v126, v166
  v_dot2_f32_bf16 v166, v47, v127, v166
  v_dot2_f32_bf16 v166, v48, v128, v166
  v_dot2_f32_bf16 v166, v49, v129, v166
  v_dot2_f32_bf16 v166, v50, v130, v166
  v_dot2_f32_bf16 v166, v51, v131, v166
  v_dot2_f32_bf16 v166, v52, v132, v166
  v_dot2_f32_bf16 v166, v53, v133, v166
  v_dot2_f32_bf16 v166, v54, v134, v166
  v_dot2_f32_bf16 v166, v55, v135, v166
  v_dot2_f32_bf16 v166, v56, v136, v166
  v_dot2_f32_bf16 v166, v57, v137, v166
  v_dot2_f32_bf16 v166, v58, v138, v166
  v_dot2_f32_bf16 v166, v59, v139, v166
  v_dot2_f32_bf16 v166, v60, v140, v166
  v_dot2_f32_bf16 v166, v61, v141, v166
  v_dot2_f32_bf16 v166, v62, v142, v166
  v_dot2_f32_bf16 v166, v63, v143, v166
  v_dot2_f32_bf16 v166, v64, v144, v166
  v_dot2_f32_bf16 v166, v65, v145, v166
  v_dot2_f32_bf16 v166, v66, v146, v166
  v_dot2_f32_bf16 v166, v67, v147, v166
  v_dot2_f32_bf16 v166, v68, v148, v166
  v_dot2_f32_bf16 v166, v69, v149, v166
  v_dot2_f32_bf16 v166, v70, v150, v166
  v_dot2_f32_bf16 v166, v71, v151, v166
  v_dot2_f32_bf16 v166, v72, v152, v166
  v_dot2_f32_bf16 v166, v73, v153, v166
  v_dot2_f32_bf16 v166, v74, v154, v166
  v_dot2_f32_bf16 v166, v75, v155, v166
  v_dot2_f32_bf16 v166, v76, v156, v166
  v_dot2_f32_bf16 v166, v77, v157, v166
  v_dot2_f32_bf16 v166, v78, v158, v166
  v_dot2_f32_bf16 v166, v79, v159, v166
  v_dot2_f32_bf16 v166, v80, v160, v166
  v_dot2_f32_bf16 v166, v81, v161, v166
  v_dot2_f32_bf16 v166, v82, v162, v166
  v_dot2_f32_bf16 v166, v83, v163, v166
  s_nop 3
  v_add_f32_dpp v9, v166, v166 quad_perm:[1,0,3,2] row_mask:0xf bank_mask:0xf
  s_nop 1
  v_add_f32_dpp v8, v9, v9 quad_perm:[2,3,0,1] row_mask:0xf bank_mask:0xf
  v_mul_f32 v8, 0xbfb8aa3b, v8
  v_exp_f32 v8, v8
  s_nop 0
  v_add_f32 v8, 1.0, v8
  v_rcp_f32 v8, v8
  v_lshlrev_b32 v9, 2, v2
  s_mov_b32 s11, 9437184
  v_cmp_eq_u32 vcc, 0, v3
  s_nop 1
  s_and_saveexec_b64 s[12:13], vcc
  buffer_store_dword v8, v9, s[4:7], s11 offen
  s_mov_b64 exec, s[12:13]
  s_barrier
  v_lshlrev_b32 v5, 4, v1
  v_lshrrev_b32 v2, 4, v1
  v_bfe_u32 v3, v1, 2, 2
  v_and_b32 v4, 3, v1
  v_lshl_add_u32 v2, v2, 3, v3
  v_mul_u32_u24 v2, 1280, v2
  v_lshl_add_u32 v2, v4, 3, v2
  s_lshl_b32 s16, s8, 5
  v_add_u32 v2, s16, v2
  ds_read_b64_tr_b16 v[16:17], v2 offset:0
  ds_read_b64_tr_b16 v[18:19], v2 offset:5120
  ds_read_b64_tr_b16 v[20:21], v2 offset:128
  ds_read_b64_tr_b16 v[22:23], v2 offset:5248
  ds_read_b64_tr_b16 v[24:25], v2 offset:256
  ds_read_b64_tr_b16 v[26:27], v2 offset:5376
  ds_read_b64_tr_b16 v[28:29], v2 offset:384
  ds_read_b64_tr_b16 v[30:31], v2 offset:5504
  ds_read_b64_tr_b16 v[32:33], v2 offset:512
  ds_read_b64_tr_b16 v[34:35], v2 offset:5632
  ds_read_b64_tr_b16 v[36:37], v2 offset:640
  ds_read_b64_tr_b16 v[38:39], v2 offset:5760
  ds_read_b64_tr_b16 v[40:41], v2 offset:768
  ds_read_b64_tr_b16 v[42:43], v2 offset:5888
  ds_read_b64_tr_b16 v[44:45], v2 offset:896
  ds_read_b64_tr_b16 v[46:47], v2 offset:6016
  ds_read_b64_tr_b16 v[48:49], v2 offset:1024
  ds_read_b64_tr_b16 v[50:51], v2 offset:6144
  ds_read_b64_tr_b16 v[52:53], v2 offset:1152
  ds_read_b64_tr_b16 v[54:55], v2 offset:6272
  s_waitcnt lgkmcnt(0)
  s_mul_i32 s19, s8, 40
  s_add_u32 s19, s19, s9
  s_add_u32 s19, s19, 0
  s_lshl_b32 s19, s19, 10
  s_add_u32 s19, s19, 29360128
  buffer_store_dwordx4 v[16:19], v5, s[4:7], s19 offen
  s_nop 1
  s_add_u32 s19, s19, 163840
  buffer_store_dwordx4 v[20:23], v5, s[4:7], s19 offen
  s_nop 1
  s_add_u32 s19, s19, 163840
  buffer_store_dwordx4 v[24:27], v5, s[4:7], s19 offen
  s_nop 1
  s_add_u32 s19, s19, 163840
  buffer_store_dwordx4 v[28:31], v5, s[4:7], s19 offen
  s_nop 1
  s_add_u32 s19, s19, 163840
  buffer_store_dwordx4 v[32:35], v5, s[4:7], s19 offen
  s_nop 1
  s_add_u32 s19, s19, 163840
  buffer_store_dwordx4 v[36:39], v5, s[4:7], s19 offen
  s_nop 1
  s_add_u32 s19, s19, 163840
  buffer_store_dwordx4 v[40:43], v5, s[4:7], s19 offen
  s_nop 1
  s_add_u32 s19, s19, 163840
  buffer_store_dwordx4 v[44:47], v5, s[4:7], s19 offen
  s_nop 1
  s_add_u32 s19, s19, 163840
  buffer_store_dwordx4 v[48:51], v5, s[4:7], s19 offen
  s_nop 1
  s_add_u32 s19, s19, 163840
  buffer_store_dwordx4 v[52:55], v5, s[4:7], s19 offen
  s_nop 1
  s_add_u32 s19, s19, 163840
  v_add_u32 v2, 40960, v2
  ds_read_b64_tr_b16 v[56:57], v2 offset:0
  ds_read_b64_tr_b16 v[58:59], v2 offset:5120
  ds_read_b64_tr_b16 v[60:61], v2 offset:128
  ds_read_b64_tr_b16 v[62:63], v2 offset:5248
  ds_read_b64_tr_b16 v[64:65], v2 offset:256
  ds_read_b64_tr_b16 v[66:67], v2 offset:5376
  ds_read_b64_tr_b16 v[68:69], v2 offset:384
  ds_read_b64_tr_b16 v[70:71], v2 offset:5504
  ds_read_b64_tr_b16 v[72:73], v2 offset:512
  ds_read_b64_tr_b16 v[74:75], v2 offset:5632
  ds_read_b64_tr_b16 v[76:77], v2 offset:640
  ds_read_b64_tr_b16 v[78:79], v2 offset:5760
  ds_read_b64_tr_b16 v[80:81], v2 offset:768
  ds_read_b64_tr_b16 v[82:83], v2 offset:5888
  ds_read_b64_tr_b16 v[84:85], v2 offset:896
  ds_read_b64_tr_b16 v[86:87], v2 offset:6016
  ds_read_b64_tr_b16 v[88:89], v2 offset:1024
  ds_read_b64_tr_b16 v[90:91], v2 offset:6144
  ds_read_b64_tr_b16 v[92:93], v2 offset:1152
  ds_read_b64_tr_b16 v[94:95], v2 offset:6272
  s_waitcnt lgkmcnt(0)
  s_mul_i32 s19, s8, 40
  s_add_u32 s19, s19, s9
  s_add_u32 s19, s19, 16
  s_lshl_b32 s19, s19, 10
  s_add_u32 s19, s19, 29360128
  buffer_store_dwordx4 v[56:59], v5, s[4:7], s19 offen
  s_nop 1
  s_add_u32 s19, s19, 163840
  buffer_store_dwordx4 v[60:63], v5, s[4:7], s19 offen
  s_nop 1
  s_add_u32 s19, s19, 163840
  buffer_store_dwordx4 v[64:67], v5, s[4:7], s19 offen
  s_nop 1
  s_add_u32 s19, s19, 163840
  buffer_store_dwordx4 v[68:71], v5, s[4:7], s19 offen
  s_nop 1
  s_add_u32 s19, s19, 163840
  buffer_store_dwordx4 v[72:75], v5, s[4:7], s19 offen
  s_nop 1
  s_add_u32 s19, s19, 163840
  buffer_store_dwordx4 v[76:79], v5, s[4:7], s19 offen
  s_nop 1
  s_add_u32 s19, s19, 163840
  buffer_store_dwordx4 v[80:83], v5, s[4:7], s19 offen
  s_nop 1
  s_add_u32 s19, s19, 163840
  buffer_store_dwordx4 v[84:87], v5, s[4:7], s19 offen
  s_nop 1
  s_add_u32 s19, s19, 163840
  buffer_store_dwordx4 v[88:91], v5, s[4:7], s19 offen
  s_nop 1
  s_add_u32 s19, s19, 163840
  buffer_store_dwordx4 v[92:95], v5, s[4:7], s19 offen
  s_nop 1
  s_add_u32 s19, s19, 163840
  s_cmp_ge_u32 s9, 8
  s_cbranch_scc1 L_proj_kernel_end
  v_add_u32 v2, 40960, v2
  ds_read_b64_tr_b16 v[96:97], v2 offset:0
  ds_read_b64_tr_b16 v[98:99], v2 offset:5120
  ds_read_b64_tr_b16 v[100:101], v2 offset:128
  ds_read_b64_tr_b16 v[102:103], v2 offset:5248
  ds_read_b64_tr_b16 v[104:105], v2 offset:256
  ds_read_b64_tr_b16 v[106:107], v2 offset:5376
  ds_read_b64_tr_b16 v[108:109], v2 offset:384
  ds_read_b64_tr_b16 v[110:111], v2 offset:5504
  ds_read_b64_tr_b16 v[112:113], v2 offset:512
  ds_read_b64_tr_b16 v[114:115], v2 offset:5632
  ds_read_b64_tr_b16 v[116:117], v2 offset:640
  ds_read_b64_tr_b16 v[118:119], v2 offset:5760
  ds_read_b64_tr_b16 v[120:121], v2 offset:768
  ds_read_b64_tr_b16 v[122:123], v2 offset:5888
  ds_read_b64_tr_b16 v[124:125], v2 offset:896
  ds_read_b64_tr_b16 v[126:127], v2 offset:6016
  ds_read_b64_tr_b16 v[128:129], v2 offset:1024
  ds_read_b64_tr_b16 v[130:131], v2 offset:6144
  ds_read_b64_tr_b16 v[132:133], v2 offset:1152
  ds_read_b64_tr_b16 v[134:135], v2 offset:6272
  s_waitcnt lgkmcnt(0)
  s_mul_i32 s19, s8, 40
  s_add_u32 s19, s19, s9
  s_add_u32 s19, s19, 32
  s_lshl_b32 s19, s19, 10
  s_add_u32 s19, s19, 29360128
  buffer_store_dwordx4 v[96:99], v5, s[4:7], s19 offen
  s_nop 1
  s_add_u32 s19, s19, 163840
  buffer_store_dwordx4 v[100:103], v5, s[4:7], s19 offen
  s_nop 1
  s_add_u32 s19, s19, 163840
  buffer_store_dwordx4 v[104:107], v5, s[4:7], s19 offen
  s_nop 1
  s_add_u32 s19, s19, 163840
  buffer_store_dwordx4 v[108:111], v5, s[4:7], s19 offen
  s_nop 1
  s_add_u32 s19, s19, 163840
  buffer_store_dwordx4 v[112:115], v5, s[4:7], s19 offen
  s_nop 1
  s_add_u32 s19, s19, 163840
  buffer_store_dwordx4 v[116:119], v5, s[4:7], s19 offen
  s_nop 1
  s_add_u32 s19, s19, 163840
  buffer_store_dwordx4 v[120:123], v5, s[4:7], s19 offen
  s_nop 1
  s_add_u32 s19, s19, 163840
  buffer_store_dwordx4 v[124:127], v5, s[4:7], s19 offen
  s_nop 1
  s_add_u32 s19, s19, 163840
  buffer_store_dwordx4 v[128:131], v5, s[4:7], s19 offen
  s_nop 1
  s_add_u32 s19, s19, 163840
  buffer_store_dwordx4 v[132:135], v5, s[4:7], s19 offen
  s_nop 1
  s_add_u32 s19, s19, 163840
L_proj_kernel_end:
L_proj_kernel_exit:
  s_endpgm
.section .rodata,"a"
.p2align 6
.amdhsa_kernel proj_kernel
  .amdhsa_next_free_vgpr 168
  .amdhsa_next_free_sgpr 102
  .amdhsa_accum_offset 168
  .amdhsa_group_segment_fixed_size 0
  .amdhsa_kernarg_size 88
  .amdhsa_user_sgpr_count 2
  .amdhsa_user_sgpr_kernarg_segment_ptr 1
  .amdhsa_system_sgpr_workgroup_id_x 1
.end_amdhsa_kernel
.text
.globl att_kernel
.p2align 8
.type att_kernel,@function
att_kernel:
  s_cmp_ge_u32 s2, 256
  s_cbranch_scc1 L_att_kernel_exit
  s_load_dwordx2 s[4:5], s[0:1], 80
  s_load_dwordx2 s[72:73], s[0:1], 0
  s_load_dwordx4 s[76:79], s[0:1], 32
  s_load_dwordx2 s[64:65], s[0:1], 72
  v_and_b32 v1, 63, v0
  v_lshrrev_b32 v3, 6, v0
  s_nop 0
  v_readfirstlane_b32 s8, v3
  s_and_b32 s62, s2, 7
  s_lshr_b32 s63, s2, 3
  s_lshl_b32 s9, s62, 2
  s_and_b32 s10, s63, 3
  s_add_u32 s9, s9, s10
  s_lshr_b32 s10, s63, 2
  s_and_b32 s37, s8, 3
  s_lshr_b32 s38, s8, 2
  s_lshl_b32 s39, s37, 1
  s_add_u32 s39, s39, s38
  v_and_b32 v2, 31, v1
  v_lshrrev_b32 v3, 5, v1
  v_cmp_lt_u32 s[16:17], 31, v1
  v_lshlrev_b32 v209, 4, v1
  v_lshlrev_b32 v210, 4, v2
  v_lshl_add_u32 v210, v3, 3, v210
  v_add_u32 v210, 1024, v210
  v_min_u32 v213, 21, v2
  v_mul_u32_u24 v212, 384, v3
  v_lshl_add_u32 v211, v213, 4, v212
  v_add_u32 v211, 1536, v211
  s_waitcnt lgkmcnt(0)
  s_mov_b32 s6, 0x10000000
  s_mov_b32 s7, 0x00020000
  s_mov_b32 s66, 256
  s_mov_b32 s67, 0x00020000
  s_mov_b32 s74, 2621440
  s_mov_b32 s75, 0x00020000
  s_mul_i32 s57, s9, 800
  s_add_u32 s44, s78, s57
  s_addc_u32 s45, s79, 0
  s_mov_b32 s46, 800
  s_mov_b32 s47, 0x00020000
  s_cmp_lg_u32 s8, 0
  s_cbranch_scc1 L_att_kernel_nowp
  s_mov_b32 m0, 162816
  v_lshlrev_b32 v212, 4, v1
  buffer_load_dwordx4 v212, s[44:47], 0 offen lds
L_att_kernel_nowp:
  s_mul_i32 s11, s9, 196608
  s_add_u32 s11, s11, 3145728
  s_mul_i32 s18, s8, 3072
  v_add_u32 v201, s18, v209
  s_lshl_b32 s19, s10, 3
  s_lshl_b32 s20, s37, 1
  s_add_u32 s20, s20, s19
  s_lshl_b32 s21, s9, 6
  s_add_u32 s20, s20, s21
  s_mul_i32 s20, s20, 1536
  s_add_u32 s20, s20, 0
  buffer_load_dwordx4 v[4:7], v209, s[4:7], s20 offen offset:0
  buffer_load_dwordx2 v[12:13], v210, s[4:7], s20 offen offset:0
  buffer_load_dwordx4 v[8:11], v209, s[4:7], s20 offen offset:1536
  buffer_load_dwordx2 v[14:15], v210, s[4:7], s20 offen offset:1536
  s_add_u32 m0, s18, 86016
  s_add_u32 s23, s11, 0
  buffer_load_dwordx4 v201, s[4:7], s23 offen offset:0 lds
  buffer_load_dwordx4 v201, s[4:7], s23 offen offset:1024 lds
  buffer_load_dwordx4 v201, s[4:7], s23 offen offset:2048 lds
  s_add_u32 s19, s19, s39
  s_lshl_b32 s21, s19, 5
  v_add_u32 v208, s21, v2
  v_lshlrev_b32 v212, 2, v208
  s_mov_b32 s22, 9437184
  buffer_load_dword v207, v212, s[4:7], s22 offen
  s_mul_i32 s27, s38, 12288
  s_add_u32 s29, s27, 86016
  v_add_u32 v188, s29, v209
  v_add_u32 v191, s29, v210
  v_add_u32 v194, s29, v211
  s_add_u32 s29, s27, 110592
  v_add_u32 v189, s29, v209
  v_add_u32 v192, s29, v210
  v_add_u32 v195, s29, v211
  s_add_u32 s29, s27, 135168
  v_add_u32 v190, s29, v209
  v_add_u32 v193, s29, v210
  v_add_u32 v196, s29, v211
  v_mov_b32 v16, 0
  v_mov_b32 v17, 0
  v_mov_b32 v18, 0
  v_mov_b32 v19, 0
  v_mov_b32 v20, 0
  v_mov_b32 v21, 0
  v_mov_b32 v22, 0
  v_mov_b32 v23, 0
  v_mov_b32 v24, 0
  v_mov_b32 v25, 0
  v_mov_b32 v26, 0
  v_mov_b32 v27, 0
  v_mov_b32 v28, 0
  v_mov_b32 v29, 0
  v_mov_b32 v30, 0
  v_mov_b32 v31, 0
  v_mov_b32 v32, 0
  v_mov_b32 v33, 0
  v_mov_b32 v34, 0
  v_mov_b32 v35, 0
  v_mov_b32 v36, 0
  v_mov_b32 v37, 0
  v_mov_b32 v38, 0
  v_mov_b32 v39, 0
  v_mov_b32 v40, 0
  v_mov_b32 v41, 0
  v_mov_b32 v42, 0
  v_mov_b32 v43, 0
  v_mov_b32 v44, 0
  v_mov_b32 v45, 0
  v_mov_b32 v46, 0
  v_mov_b32 v47, 0
  s_waitcnt vmcnt(1)
  v_cndmask_b32 v12, v12, 0, s[16:17]
  v_cndmask_b32 v13, v13, 0, s[16:17]
  v_cndmask_b32 v14, v14, 0, s[16:17]
  v_cndmask_b32 v15, v15, 0, s[16:17]
  s_barrier
  v_add_u32 v212, 86016, v209
  v_add_u32 v213, 86016, v210
  ds_read_b128 v[88:91], v212
  ds_read_b64 v[96:97], v213
  s_waitcnt lgkmcnt(0)
  v_mfma_f32_32x32x16_bf16 v[48:63], v[88:91], v[4:7], 0
  v_mfma_f32_32x32x8bf16_1k v[48:63], v[96:97], v[12:13], v[48:63]
  v_mfma_f32_32x32x16_bf16 v[64:79], v[88:91], v[8:11], 0
  v_mfma_f32_32x32x8bf16_1k v[64:79], v[96:97], v[14:15], v[64:79]
  ds_read_b128 v[88:91], v188
  ds_read_b64 v[96:97], v191
  ds_read_b128 v[100:103], v194
  ds_read_b128 v[104:107], v194 offset:768
  s_nop 5
  v_max3_f32 v212, v48, v49, v50
  v_max3_f32 v212, v212, v51, v52
  v_max3_f32 v212, v212, v53, v54
  v_max3_f32 v212, v212, v55, v56
  v_max3_f32 v212, v212, v57, v58
  v_max3_f32 v212, v212, v59, v60
  v_max3_f32 v212, v212, v61, v62
  v_max_f32 v212, v212, v63
  v_mov_b32 v223, v212
  s_nop 1
  v_permlane32_swap_b32 v212, v223
  v_max_f32 v212, v212, v223
  v_sub_f32 v212, 0, v212
  v_cvt_pk_bf16_f32 v212, v212, 0
  v_cndmask_b32 v12, v12, v212, s[16:17]
  v_max3_f32 v212, v64, v65, v66
  v_max3_f32 v212, v212, v67, v68
  v_max3_f32 v212, v212, v69, v70
  v_max3_f32 v212, v212, v71, v72
  v_max3_f32 v212, v212, v73, v74
  v_max3_f32 v212, v212, v75, v76
  v_max3_f32 v212, v212, v77, v78
  v_max_f32 v212, v212, v79
  v_mov_b32 v223, v212
  s_nop 1
  v_permlane32_swap_b32 v212, v223
  v_max_f32 v212, v212, v223
  v_sub_f32 v212, 0, v212
  v_cvt_pk_bf16_f32 v212, v212, 0
  v_cndmask_b32 v14, v14, v212, s[16:17]
  s_waitcnt lgkmcnt(0)
  v_mfma_f32_32x32x16_bf16 v[48:63], v[88:91], v[4:7], 0
  v_mfma_f32_32x32x8bf16_1k v[48:63], v[96:97], v[12:13], v[48:63]
  v_mov_b32 v84, 0
  v_mov_b32 v112, 0
  v_mov_b32 v85, 0
  v_mov_b32 v113, 0
  v_mov_b32 v86, 0
  v_mov_b32 v114, 0
  v_mov_b32 v87, 0
  v_mov_b32 v115, 0
  v_mov_b32 v78, 0
  v_mov_b32 v79, 0
  s_nop 4
  s_waitcnt lgkmcnt(0)
  s_add_u32 m0, s18, 110592
  s_add_u32 s23, s11, 24576
  buffer_load_dwordx4 v201, s[4:7], s23 offen offset:0 lds
  buffer_load_dwordx4 v201, s[4:7], s23 offen offset:1024 lds
  buffer_load_dwordx4 v201, s[4:7], s23 offen offset:2048 lds
  ds_read_b128 v[92:95], v188 offset:3072
  ds_read_b64 v[98:99], v191 offset:3072
  v_cvt_pk_bf16_f32 v87, v78, v79
  v_mfma_f32_32x32x16_bf16 v[64:79], v[88:91], v[8:11], 0
  v_exp_f32 v48, v48
  v_exp_f32 v49, v49
  v_exp_f32 v50, v50
  v_cvt_pk_bf16_f32 v80, v48, v49
  v_exp_f32 v51, v51
  v_mfma_f32_32x32x16_bf16 v[32:47], v[112:115], v[84:87], v[32:47]
  v_exp_f32 v52, v52
  v_cvt_pk_bf16_f32 v81, v50, v51
  v_exp_f32 v53, v53
  v_exp_f32 v54, v54
  v_cvt_pk_bf16_f32 v82, v52, v53
  v_exp_f32 v55, v55
  v_mfma_f32_32x32x8bf16_1k v[64:79], v[96:97], v[14:15], v[64:79]
  v_exp_f32 v56, v56
  v_cvt_pk_bf16_f32 v83, v54, v55
  v_exp_f32 v57, v57
  v_exp_f32 v58, v58
  v_cvt_pk_bf16_f32 v84, v56, v57
  v_exp_f32 v59, v59
  v_mfma_f32_32x32x16_bf16 v[16:31], v[100:103], v[80:83], v[16:31]
  v_exp_f32 v60, v60
  v_cvt_pk_bf16_f32 v85, v58, v59
  v_exp_f32 v61, v61
  v_exp_f32 v62, v62
  v_cvt_pk_bf16_f32 v86, v60, v61
  v_exp_f32 v63, v63
  s_waitcnt lgkmcnt(0)
  s_lshl_b32 s54, s9, 6
  s_add_u32 s54, s54, s19
  s_mul_i32 s55, s54, 1536
  s_add_u32 s55, s55, 16777216
  s_mul_i32 s56, s54, 3072
  s_add_u32 s56, s56, 19922944
  buffer_load_dwordx4 v[148:151], v209, s[4:7], s55 offen
  buffer_load_dwordx2 v[152:153], v210, s[4:7], s55 offen
  buffer_load_dwordx4 v[154:157], v209, s[4:7], s56 offen
  buffer_load_dwordx2 v[158:159], v210, s[4:7], s56 offen
  buffer_load_dwordx4 v[160:163], v211, s[4:7], s56 offen
  buffer_load_dwordx4 v[164:167], v211, s[4:7], s56 offen offset:768
  ds_read_b128 v[108:111], v194 offset:3072
  v_cvt_pk_bf16_f32 v87, v62, v63
  v_mfma_f32_32x32x16_bf16 v[48:63], v[92:95], v[4:7], 0
  v_exp_f32 v64, v64
  v_exp_f32 v65, v65
  v_exp_f32 v66, v66
  v_cvt_pk_bf16_f32 v80, v64, v65
  v_exp_f32 v67, v67
  v_mfma_f32_32x32x16_bf16 v[16:31], v[104:107], v[84:87], v[16:31]
  ds_read_b128 v[112:115], v194 offset:3840
  v_exp_f32 v68, v68
  v_cvt_pk_bf16_f32 v81, v66, v67
  v_exp_f32 v69, v69
  v_exp_f32 v70, v70
  v_cvt_pk_bf16_f32 v82, v68, v69
  v_exp_f32 v71, v71
  v_mfma_f32_32x32x8bf16_1k v[48:63], v[98:99], v[12:13], v[48:63]
  v_exp_f32 v72, v72
  v_cvt_pk_bf16_f32 v83, v70, v71
  v_exp_f32 v73, v73
  v_exp_f32 v74, v74
  v_cvt_pk_bf16_f32 v84, v72, v73
  v_exp_f32 v75, v75
  v_mfma_f32_32x32x16_bf16 v[32:47], v[100:103], v[80:83], v[32:47]
  v_exp_f32 v76, v76
  v_cvt_pk_bf16_f32 v85, v74, v75
  v_exp_f32 v77, v77
  v_exp_f32 v78, v78
  v_cvt_pk_bf16_f32 v86, v76, v77
  v_exp_f32 v79, v79
  s_waitcnt lgkmcnt(0)
  ds_read_b128 v[88:91], v188 offset:6144
  ds_read_b64 v[96:97], v191 offset:6144
  v_cvt_pk_bf16_f32 v87, v78, v79
  v_mfma_f32_32x32x16_bf16 v[64:79], v[92:95], v[8:11], 0
  v_exp_f32 v48, v48
  v_exp_f32 v49, v49
  v_exp_f32 v50, v50
  v_cvt_pk_bf16_f32 v80, v48, v49
  v_exp_f32 v51, v51
  v_mfma_f32_32x32x16_bf16 v[32:47], v[104:107], v[84:87], v[32:47]
  v_exp_f32 v52, v52
  v_cvt_pk_bf16_f32 v81, v50, v51
  v_exp_f32 v53, v53
  v_exp_f32 v54, v54
  v_cvt_pk_bf16_f32 v82, v52, v53
  v_exp_f32 v55, v55
  v_mfma_f32_32x32x8bf16_1k v[64:79], v[98:99], v[14:15], v[64:79]
  v_exp_f32 v56, v56
  v_cvt_pk_bf16_f32 v83, v54, v55
  v_exp_f32 v57, v57
  v_exp_f32 v58, v58
  v_cvt_pk_bf16_f32 v84, v56, v57
  v_exp_f32 v59, v59
  v_mfma_f32_32x32x16_bf16 v[16:31], v[108:111], v[80:83], v[16:31]
  v_exp_f32 v60, v60
  v_cvt_pk_bf16_f32 v85, v58, v59
  v_exp_f32 v61, v61
  v_exp_f32 v62, v62
  v_cvt_pk_bf16_f32 v86, v60, v61
  v_exp_f32 v63, v63
  s_waitcnt lgkmcnt(0)
  ds_read_b128 v[100:103], v194 offset:6144
  v_cvt_pk_bf16_f32 v87, v62, v63
  v_mfma_f32_32x32x16_bf16 v[48:63], v[88:91], v[4:7], 0
  v_exp_f32 v64, v64
  v_exp_f32 v65, v65
  v_exp_f32 v66, v66
  v_cvt_pk_bf16_f32 v80, v64, v65
  v_exp_f32 v67, v67
  v_mfma_f32_32x32x16_bf16 v[16:31], v[112:115], v[84:87], v[16:31]
  ds_read_b128 v[104:107], v194 offset:6912
  v_exp_f32 v68, v68
  v_cvt_pk_bf16_f32 v81, v66, v67
  v_exp_f32 v69, v69
  v_exp_f32 v70, v70
  v_cvt_pk_bf16_f32 v82, v68, v69
  v_exp_f32 v71, v71
  v_mfma_f32_32x32x8bf16_1k v[48:63], v[96:97], v[12:13], v[48:63]
  v_exp_f32 v72, v72
  v_cvt_pk_bf16_f32 v83, v70, v71
  v_exp_f32 v73, v73
  v_exp_f32 v74, v74
  v_cvt_pk_bf16_f32 v84, v72, v73
  v_exp_f32 v75, v75
  v_mfma_f32_32x32x16_bf16 v[32:47], v[108:111], v[80:83], v[32:47]
  v_exp_f32 v76, v76
  v_cvt_pk_bf16_f32 v85, v74, v75
  v_exp_f32 v77, v77
  v_exp_f32 v78, v78
  v_cvt_pk_bf16_f32 v86, v76, v77
  v_exp_f32 v79, v79
  s_waitcnt lgkmcnt(0)
  ds_read_b128 v[92:95], v188 offset:9216
  ds_read_b64 v[98:99], v191 offset:9216
  v_cvt_pk_bf16_f32 v87, v78, v79
  v_mfma_f32_32x32x16_bf16 v[64:79], v[88:91], v[8:11], 0
  v_exp_f32 v48, v48
  v_exp_f32 v49, v49
  v_exp_f32 v50, v50
  v_cvt_pk_bf16_f32 v80, v48, v49
  v_exp_f32 v51, v51
  v_mfma_f32_32x32x16_bf16 v[32:47], v[112:115], v[84:87], v[32:47]
  v_exp_f32 v52, v52
  v_cvt_pk_bf16_f32 v81, v50, v51
  v_exp_f32 v53, v53
  v_exp_f32 v54, v54
  v_cvt_pk_bf16_f32 v82, v52, v53
  v_exp_f32 v55, v55
  v_mfma_f32_32x32x8bf16_1k v[64:79], v[96:97], v[14:15], v[64:79]
  v_exp_f32 v56, v56
  v_cvt_pk_bf16_f32 v83, v54, v55
  v_exp_f32 v57, v57
  v_exp_f32 v58, v58
  v_cvt_pk_bf16_f32 v84, v56, v57
  v_exp_f32 v59, v59
  v_mfma_f32_32x32x16_bf16 v[16:31], v[100:103], v[80:83], v[16:31]
  v_exp_f32 v60, v60
  v_cvt_pk_bf16_f32 v85, v58, v59
  v_exp_f32 v61, v61
  v_exp_f32 v62, v62
  v_cvt_pk_bf16_f32 v86, v60, v61
  v_exp_f32 v63, v63
  s_waitcnt lgkmcnt(0)
  ds_read_b128 v[108:111], v194 offset:9216
  v_cvt_pk_bf16_f32 v87, v62, v63
  v_mfma_f32_32x32x16_bf16 v[48:63], v[92:95], v[4:7], 0
  v_exp_f32 v64, v64
  v_exp_f32 v65, v65
  v_exp_f32 v66, v66
  v_cvt_pk_bf16_f32 v80, v64, v65
  v_exp_f32 v67, v67
  v_mfma_f32_32x32x16_bf16 v[16:31], v[104:107], v[84:87], v[16:31]
  ds_read_b128 v[112:115], v194 offset:9984
  v_exp_f32 v68, v68
  v_cvt_pk_bf16_f32 v81, v66, v67
  v_exp_f32 v69, v69
  v_exp_f32 v70, v70
  v_cvt_pk_bf16_f32 v82, v68, v69
  v_exp_f32 v71, v71
  v_mfma_f32_32x32x8bf16_1k v[48:63], v[98:99], v[12:13], v[48:63]
  v_exp_f32 v72, v72
  v_cvt_pk_bf16_f32 v83, v70, v71
  v_exp_f32 v73, v73
  v_exp_f32 v74, v74
  v_cvt_pk_bf16_f32 v84, v72, v73
  v_exp_f32 v75, v75
  v_mfma_f32_32x32x16_bf16 v[32:47], v[100:103], v[80:83], v[32:47]
  v_exp_f32 v76, v76
  v_cvt_pk_bf16_f32 v85, v74, v75
  v_exp_f32 v77, v77
  v_exp_f32 v78, v78
  v_cvt_pk_bf16_f32 v86, v76, v77
  v_exp_f32 v79, v79
  s_waitcnt lgkmcnt(0)
  s_waitcnt vmcnt(6)
  s_barrier
  s_add_u32 m0, s18, 135168
  s_add_u32 s23, s11, 49152
  buffer_load_dwordx4 v201, s[4:7], s23 offen offset:0 lds
  buffer_load_dwordx4 v201, s[4:7], s23 offen offset:1024 lds
  buffer_load_dwordx4 v201, s[4:7], s23 offen offset:2048 lds
  s_cmp_lg_u32 s8, 0
  s_cbranch_scc1 L_att_kernel_nopk
  v_subrev_u32 v212, 2, v2
  v_cmp_gt_u32 vcc, 18, v2
  s_nop 1
  v_cndmask_b32 v212, v212, v2, vcc
  v_subrev_u32 v213, 18, v2
  v_cmp_gt_u32 vcc, 2, v213
  v_cmp_lt_u32 s[58:59], 21, v2
  s_nop 1
  s_or_b64 s[58:59], vcc, s[58:59]
  v_cndmask_b32 v212, v212, 0, s[58:59]
  v_lshlrev_b32 v212, 1, v212
  v_add_u32 v212, 162816, v212
  v_mul_u32_u24 v214, 320, v3
  v_add_u32 v214, v214, v212
  s_or_b64 s[60:61], s[58:59], s[16:17]
  v_lshlrev_b32 v216, 2, v1
  v_add_u32 v216, 159744, v216
  ds_read_u16 v172, v214 offset:0
  ds_read_u16 v173, v214 offset:40
  ds_read_u16 v174, v214 offset:80
  ds_read_u16 v175, v214 offset:120
  ds_read_u16 v176, v214 offset:160
  ds_read_u16 v177, v214 offset:200
  ds_read_u16 v178, v214 offset:240
  ds_read_u16 v179, v214 offset:280
  s_waitcnt lgkmcnt(0)
  v_lshl_or_b32 v180, v173, 16, v172
  v_cndmask_b32 v180, v180, 0, s[58:59]
  ds_write_b32 v216, v180 offset:0
  v_lshl_or_b32 v181, v175, 16, v174
  v_cndmask_b32 v181, v181, 0, s[58:59]
  ds_write_b32 v216, v181 offset:256
  v_lshl_or_b32 v182, v177, 16, v176
  v_cndmask_b32 v182, v182, 0, s[58:59]
  ds_write_b32 v216, v182 offset:512
  v_lshl_or_b32 v183, v179, 16, v178
  v_cndmask_b32 v183, v183, 0, s[58:59]
  ds_write_b32 v216, v183 offset:768
  ds_read_u16 v172, v212 offset:640
  ds_read_u16 v173, v212 offset:680
  ds_read_u16 v174, v212 offset:720
  ds_read_u16 v175, v212 offset:760
  s_waitcnt lgkmcnt(0)
  v_lshl_or_b32 v180, v173, 16, v172
  v_cndmask_b32 v180, v180, 0, s[60:61]
  ds_write_b32 v216, v180 offset:1024
  v_lshl_or_b32 v181, v175, 16, v174
  v_cndmask_b32 v181, v181, 0, s[60:61]
  ds_write_b32 v216, v181 offset:1280
L_att_kernel_nopk:
  ds_read_b128 v[88:91], v189 offset:0
  ds_read_b64 v[96:97], v192 offset:0
  v_cvt_pk_bf16_f32 v87, v78, v79
  v_mfma_f32_32x32x16_bf16 v[64:79], v[92:95], v[8:11], 0
  v_exp_f32 v48, v48
  v_exp_f32 v49, v49
  v_exp_f32 v50, v50
  v_cvt_pk_bf16_f32 v80, v48, v49
  v_exp_f32 v51, v51
  v_mfma_f32_32x32x16_bf16 v[32:47], v[104:107], v[84:87], v[32:47]
  v_exp_f32 v52, v52
  v_cvt_pk_bf16_f32 v81, v50, v51
  v_exp_f32 v53, v53
  v_exp_f32 v54, v54
  v_cvt_pk_bf16_f32 v82, v52, v53
  v_exp_f32 v55, v55
  v_mfma_f32_32x32x8bf16_1k v[64:79], v[98:99], v[14:15], v[64:79]
  v_exp_f32 v56, v56
  v_cvt_pk_bf16_f32 v83, v54, v55
  v_exp_f32 v57, v57
  v_exp_f32 v58, v58
  v_cvt_pk_bf16_f32 v84, v56, v57
  v_exp_f32 v59, v59
  v_mfma_f32_32x32x16_bf16 v[16:31], v[108:111], v[80:83], v[16:31]
  v_exp_f32 v60, v60
  v_cvt_pk_bf16_f32 v85, v58, v59
  v_exp_f32 v61, v61
  v_exp_f32 v62, v62
  v_cvt_pk_bf16_f32 v86, v60, v61
  v_exp_f32 v63, v63
  s_waitcnt lgkmcnt(0)
  ds_read_b128 v[100:103], v195 offset:0
  v_cvt_pk_bf16_f32 v87, v62, v63
  v_mfma_f32_32x32x16_bf16 v[48:63], v[88:91], v[4:7], 0
  v_exp_f32 v64, v64
  v_exp_f32 v65, v65
  v_exp_f32 v66, v66
  v_cvt_pk_bf16_f32 v80, v64, v65
  v_exp_f32 v67, v67
  v_mfma_f32_32x32x16_bf16 v[16:31], v[112:115], v[84:87], v[16:31]
  ds_read_b128 v[104:107], v195 offset:768
  v_exp_f32 v68, v68
  v_cvt_pk_bf16_f32 v81, v66, v67
  v_exp_f32 v69, v69
  v_exp_f32 v70, v70
  v_cvt_pk_bf16_f32 v82, v68, v69
  v_exp_f32 v71, v71
  v_mfma_f32_32x32x8bf16_1k v[48:63], v[96:97], v[12:13], v[48:63]
  v_exp_f32 v72, v72
  v_cvt_pk_bf16_f32 v83, v70, v71
  v_exp_f32 v73, v73
  v_exp_f32 v74, v74
  v_cvt_pk_bf16_f32 v84, v72, v73
  v_exp_f32 v75, v75
  v_mfma_f32_32x32x16_bf16 v[32:47], v[108:111], v[80:83], v[32:47]
  v_exp_f32 v76, v76
  v_cvt_pk_bf16_f32 v85, v74, v75
  v_exp_f32 v77, v77
  v_exp_f32 v78, v78
  v_cvt_pk_bf16_f32 v86, v76, v77
  v_exp_f32 v79, v79
  s_waitcnt lgkmcnt(0)
  ds_read_b128 v[92:95], v189 offset:3072
  ds_read_b64 v[98:99], v192 offset:3072
  v_cvt_pk_bf16_f32 v87, v78, v79
  v_mfma_f32_32x32x16_bf16 v[64:79], v[88:91], v[8:11], 0
  v_exp_f32 v48, v48
  v_exp_f32 v49, v49
  v_exp_f32 v50, v50
  v_cvt_pk_bf16_f32 v80, v48, v49
  v_exp_f32 v51, v51
  v_mfma_f32_32x32x16_bf16 v[32:47], v[112:115], v[84:87], v[32:47]
  v_exp_f32 v52, v52
  v_cvt_pk_bf16_f32 v81, v50, v51
  v_exp_f32 v53, v53
  v_exp_f32 v54, v54
  v_cvt_pk_bf16_f32 v82, v52, v53
  v_exp_f32 v55, v55
  v_mfma_f32_32x32x8bf16_1k v[64:79], v[96:97], v[14:15], v[64:79]
  v_exp_f32 v56, v56
  v_cvt_pk_bf16_f32 v83, v54, v55
  v_exp_f32 v57, v57
  v_exp_f32 v58, v58
  v_cvt_pk_bf16_f32 v84, v56, v57
  v_exp_f32 v59, v59
  v_mfma_f32_32x32x16_bf16 v[16:31], v[100:103], v[80:83], v[16:31]
  v_exp_f32 v60, v60
  v_cvt_pk_bf16_f32 v85, v58, v59
  v_exp_f32 v61, v61
  v_exp_f32 v62, v62
  v_cvt_pk_bf16_f32 v86, v60, v61
  v_exp_f32 v63, v63
  s_waitcnt lgkmcnt(0)
  ds_read_b128 v[108:111], v195 offset:3072
  v_cvt_pk_bf16_f32 v87, v62, v63
  v_mfma_f32_32x32x16_bf16 v[48:63], v[92:95], v[4:7], 0
  v_exp_f32 v64, v64
  v_exp_f32 v65, v65
  v_exp_f32 v66, v66
  v_cvt_pk_bf16_f32 v80, v64, v65
  v_exp_f32 v67, v67
  v_mfma_f32_32x32x16_bf16 v[16:31], v[104:107], v[84:87], v[16:31]
  ds_read_b128 v[112:115], v195 offset:3840
  v_exp_f32 v68, v68
  v_cvt_pk_bf16_f32 v81, v66, v67
  v_exp_f32 v69, v69
  v_exp_f32 v70, v70
  v_cvt_pk_bf16_f32 v82, v68, v69
  v_exp_f32 v71, v71
  v_mfma_f32_32x32x8bf16_1k v[48:63], v[98:99], v[12:13], v[48:63]
  v_exp_f32 v72, v72
  v_cvt_pk_bf16_f32 v83, v70, v71
  v_exp_f32 v73, v73
  v_exp_f32 v74, v74
  v_cvt_pk_bf16_f32 v84, v72, v73
  v_exp_f32 v75, v75
  v_mfma_f32_32x32x16_bf16 v[32:47], v[100:103], v[80:83], v[32:47]
  v_exp_f32 v76, v76
  v_cvt_pk_bf16_f32 v85, v74, v75
  v_exp_f32 v77, v77
  v_exp_f32 v78, v78
  v_cvt_pk_bf16_f32 v86, v76, v77
  v_exp_f32 v79, v79
  s_waitcnt lgkmcnt(0)
  ds_read_b128 v[88:91], v189 offset:6144
  ds_read_b64 v[96:97], v192 offset:6144
  v_cvt_pk_bf16_f32 v87, v78, v79
  v_mfma_f32_32x32x16_bf16 v[64:79], v[92:95], v[8:11], 0
  v_exp_f32 v48, v48
  v_exp_f32 v49, v49
  v_exp_f32 v50, v50
  v_cvt_pk_bf16_f32 v80, v48, v49
  v_exp_f32 v51, v51
  v_mfma_f32_32x32x16_bf16 v[32:47], v[104:107], v[84:87], v[32:47]
  v_exp_f32 v52, v52
  v_cvt_pk_bf16_f32 v81, v50, v51
  v_exp_f32 v53, v53
  v_exp_f32 v54, v54
  v_cvt_pk_bf16_f32 v82, v52, v53
  v_exp_f32 v55, v55
  v_mfma_f32_32x32x8bf16_1k v[64:79], v[98:99], v[14:15], v[64:79]
  v_exp_f32 v56, v56
  v_cvt_pk_bf16_f32 v83, v54, v55
  v_exp_f32 v57, v57
  v_exp_f32 v58, v58
  v_cvt_pk_bf16_f32 v84, v56, v57
  v_exp_f32 v59, v59
  v_mfma_f32_32x32x16_bf16 v[16:31], v[108:111], v[80:83], v[16:31]
  v_exp_f32 v60, v60
  v_cvt_pk_bf16_f32 v85, v58, v59
  v_exp_f32 v61, v61
  v_exp_f32 v62, v62
  v_cvt_pk_bf16_f32 v86, v60, v61
  v_exp_f32 v63, v63
  s_waitcnt lgkmcnt(0)
  ds_read_b128 v[100:103], v195 offset:6144
  v_cvt_pk_bf16_f32 v87, v62, v63
  v_mfma_f32_32x32x16_bf16 v[48:63], v[88:91], v[4:7], 0
  v_exp_f32 v64, v64
  v_exp_f32 v65, v65
  v_exp_f32 v66, v66
  v_cvt_pk_bf16_f32 v80, v64, v65
  v_exp_f32 v67, v67
  v_mfma_f32_32x32x16_bf16 v[16:31], v[112:115], v[84:87], v[16:31]
  ds_read_b128 v[104:107], v195 offset:6912
  v_exp_f32 v68, v68
  v_cvt_pk_bf16_f32 v81, v66, v67
  v_exp_f32 v69, v69
  v_exp_f32 v70, v70
  v_cvt_pk_bf16_f32 v82, v68, v69
  v_exp_f32 v71, v71
  v_mfma_f32_32x32x8bf16_1k v[48:63], v[96:97], v[12:13], v[48:63]
  v_exp_f32 v72, v72
  v_cvt_pk_bf16_f32 v83, v70, v71
  v_exp_f32 v73, v73
  v_exp_f32 v74, v74
  v_cvt_pk_bf16_f32 v84, v72, v73
  v_exp_f32 v75, v75
  v_mfma_f32_32x32x16_bf16 v[32:47], v[108:111], v[80:83], v[32:47]
  v_exp_f32 v76, v76
  v_cvt_pk_bf16_f32 v85, v74, v75
  v_exp_f32 v77, v77
  v_exp_f32 v78, v78
  v_cvt_pk_bf16_f32 v86, v76, v77
  v_exp_f32 v79, v79
  s_waitcnt lgkmcnt(0)
  ds_read_b128 v[92:95], v189 offset:9216
  ds_read_b64 v[98:99], v192 offset:9216
  v_cvt_pk_bf16_f32 v87, v78, v79
  v_mfma_f32_32x32x16_bf16 v[64:79], v[88:91], v[8:11], 0
  v_exp_f32 v48, v48
  v_exp_f32 v49, v49
  v_exp_f32 v50, v50
  v_cvt_pk_bf16_f32 v80, v48, v49
  v_exp_f32 v51, v51
  v_mfma_f32_32x32x16_bf16 v[32:47], v[112:115], v[84:87], v[32:47]
  v_exp_f32 v52, v52
  v_cvt_pk_bf16_f32 v81, v50, v51
  v_exp_f32 v53, v53
  v_exp_f32 v54, v54
  v_cvt_pk_bf16_f32 v82, v52, v53
  v_exp_f32 v55, v55
  v_mfma_f32_32x32x8bf16_1k v[64:79], v[96:97], v[14:15], v[64:79]
  v_exp_f32 v56, v56
  v_cvt_pk_bf16_f32 v83, v54, v55
  v_exp_f32 v57, v57
  v_exp_f32 v58, v58
  v_cvt_pk_bf16_f32 v84, v56, v57
  v_exp_f32 v59, v59
  v_mfma_f32_32x32x16_bf16 v[16:31], v[100:103], v[80:83], v[16:31]
  v_exp_f32 v60, v60
  v_cvt_pk_bf16_f32 v85, v58, v59
  v_exp_f32 v61, v61
  v_exp_f32 v62, v62
  v_cvt_pk_bf16_f32 v86, v60, v61
  v_exp_f32 v63, v63
  s_waitcnt lgkmcnt(0)
  ds_read_b128 v[108:111], v195 offset:9216
  v_cvt_pk_bf16_f32 v87, v62, v63
  v_mfma_f32_32x32x16_bf16 v[48:63], v[92:95], v[4:7], 0
  v_exp_f32 v64, v64
  v_exp_f32 v65, v65
  v_exp_f32 v66, v66
  v_cvt_pk_bf16_f32 v80, v64, v65
  v_exp_f32 v67, v67
  v_mfma_f32_32x32x16_bf16 v[16:31], v[104:107], v[84:87], v[16:31]
  ds_read_b128 v[112:115], v195 offset:9984
  v_exp_f32 v68, v68
  v_cvt_pk_bf16_f32 v81, v66, v67
  v_exp_f32 v69, v69
  v_exp_f32 v70, v70
  v_cvt_pk_bf16_f32 v82, v68, v69
  v_exp_f32 v71, v71
  v_mfma_f32_32x32x8bf16_1k v[48:63], v[98:99], v[12:13], v[48:63]
  v_exp_f32 v72, v72
  v_cvt_pk_bf16_f32 v83, v70, v71
  v_exp_f32 v73, v73
  v_exp_f32 v74, v74
  v_cvt_pk_bf16_f32 v84, v72, v73
  v_exp_f32 v75, v75
  v_mfma_f32_32x32x16_bf16 v[32:47], v[100:103], v[80:83], v[32:47]
  v_exp_f32 v76, v76
  v_cvt_pk_bf16_f32 v85, v74, v75
  v_exp_f32 v77, v77
  v_exp_f32 v78, v78
  v_cvt_pk_bf16_f32 v86, v76, v77
  v_exp_f32 v79, v79
  s_waitcnt lgkmcnt(0)
  s_waitcnt vmcnt(0)
  s_barrier
  s_add_u32 m0, s18, 86016
  s_add_u32 s23, s11, 73728
  buffer_load_dwordx4 v201, s[4:7], s23 offen offset:0 lds
  buffer_load_dwordx4 v201, s[4:7], s23 offen offset:1024 lds
  buffer_load_dwordx4 v201, s[4:7], s23 offen offset:2048 lds
  s_nop 4
  v_lshlrev_b32 v212, 2, v1
  v_add_u32 v212, 159744, v212
  ds_read_b32 v168, v212 offset:0
  ds_read_b32 v169, v212 offset:256
  ds_read_b32 v170, v212 offset:512
  ds_read_b32 v171, v212 offset:768
  ds_read_b32 v172, v212 offset:1024
  ds_read_b32 v173, v212 offset:1280
  v_cndmask_b32 v152, v152, 0, s[16:17]
  v_cndmask_b32 v153, v153, 0, s[16:17]
  s_waitcnt lgkmcnt(0)
  s_mov_b32 s57, 1069066811
  s_mul_i32 s58, s8, 6144
  s_add_u32 s58, s58, 20480
  v_mfma_f32_32x32x16_bf16 v[224:239], v[168:171], v[148:151], 0
  v_mfma_f32_32x32x8bf16_1k v[224:239], v[172:173], v[152:153], v[224:239]
  s_nop 11
  v_max3_f32 v212, v224, v225, v226
  v_min3_f32 v213, v224, v225, v226
  v_max3_f32 v212, v212, v227, v228
  v_min3_f32 v213, v213, v227, v228
  v_max3_f32 v212, v212, v229, v230
  v_min3_f32 v213, v213, v229, v230
  v_max3_f32 v212, v212, v231, v232
  v_min3_f32 v213, v213, v231, v232
  v_max_f32 v212, v212, v233
  v_min_f32 v213, v213, v233
  v_mov_b32 v214, v212
  s_nop 1
  v_permlane32_swap_b32 v212, v214
  v_max_f32 v212, v212, v214
  v_mov_b32 v214, v213
  s_nop 1
  v_permlane32_swap_b32 v213, v214
  v_min_f32 v213, v213, v214
  v_mul_f32 v212, s57, v212
  v_mul_f32 v213, s57, v213
  v_fma_f32 v116, v224, s57, -v212
  v_fma_f32 v132, -v224, s57, v213
  v_fma_f32 v117, v225, s57, -v212
  v_fma_f32 v133, -v225, s57, v213
  v_fma_f32 v118, v226, s57, -v212
  v_fma_f32 v134, -v226, s57, v213
  v_fma_f32 v119, v227, s57, -v212
  v_fma_f32 v135, -v227, s57, v213
  v_fma_f32 v120, v228, s57, -v212
  v_fma_f32 v136, -v228, s57, v213
  v_fma_f32 v121, v229, s57, -v212
  v_fma_f32 v137, -v229, s57, v213
  v_fma_f32 v122, v230, s57, -v212
  v_fma_f32 v138, -v230, s57, v213
  v_fma_f32 v123, v231, s57, -v212
  v_fma_f32 v139, -v231, s57, v213
  v_fma_f32 v124, v232, s57, -v212
  v_fma_f32 v140, -v232, s57, v213
  v_fma_f32 v125, v233, s57, -v212
  v_fma_f32 v141, -v233, s57, v213
  v_exp_f32 v116, v116
  v_exp_f32 v132, v132
  v_exp_f32 v117, v117
  v_exp_f32 v133, v133
  v_exp_f32 v118, v118
  v_exp_f32 v134, v134
  v_exp_f32 v119, v119
  v_exp_f32 v135, v135
  v_exp_f32 v120, v120
  v_exp_f32 v136, v136
  v_exp_f32 v121, v121
  v_exp_f32 v137, v137
  v_exp_f32 v122, v122
  v_exp_f32 v138, v138
  v_exp_f32 v123, v123
  v_exp_f32 v139, v139
  v_exp_f32 v124, v124
  v_exp_f32 v140, v140
  v_exp_f32 v125, v125
  v_exp_f32 v141, v141
  v_cvt_pk_bf16_f32 v240, v116, v117
  v_cvt_pk_bf16_f32 v241, v118, v119
  v_cvt_pk_bf16_f32 v242, v120, v121
  v_cvt_pk_bf16_f32 v243, v122, v123
  v_cvt_pk_bf16_f32 v244, v124, v125
  v_mov_b32 v245, 0
  v_cvt_pk_bf16_f32 v246, v132, v133
  v_cvt_pk_bf16_f32 v247, v134, v135
  v_cvt_pk_bf16_f32 v248, v136, v137
  v_cvt_pk_bf16_f32 v249, v138, v139
  v_cvt_pk_bf16_f32 v250, v140, v141
  v_mov_b32 v251, 0
  s_mul_i32 s59, s8, 2560
  s_add_u32 s59, s59, 0
  v_lshlrev_b32 v214, 2, v1
  v_add_u32 v214, s59, v214
  ds_write_b32 v214, v240 offset:0
  ds_write_b32 v214, v241 offset:256
  ds_write_b32 v214, v242 offset:512
  ds_write_b32 v214, v243 offset:768
  ds_write_b32 v214, v244 offset:1024
  ds_write_b32 v214, v246 offset:1280
  ds_write_b32 v214, v247 offset:1536
  ds_write_b32 v214, v248 offset:1792
  ds_write_b32 v214, v249 offset:2048
  ds_write_b32 v214, v250 offset:2304
  v_mfma_f32_32x32x16_bf16 v[224:239], v[168:171], v[154:157], 0
  v_mfma_f32_32x32x8bf16_1k v[224:239], v[172:173], v[158:159], v[224:239]
  s_nop 11
  v_max3_f32 v212, v224, v225, v226
  v_min3_f32 v213, v224, v225, v226
  v_max3_f32 v212, v212, v227, v228
  v_min3_f32 v213, v213, v227, v228
  v_max3_f32 v212, v212, v229, v230
  v_min3_f32 v213, v213, v229, v230
  v_max3_f32 v212, v212, v231, v232
  v_min3_f32 v213, v213, v231, v232
  v_max_f32 v212, v212, v233
  v_min_f32 v213, v213, v233
  v_mov_b32 v214, v212
  s_nop 1
  v_permlane32_swap_b32 v212, v214
  v_max_f32 v212, v212, v214
  v_mov_b32 v214, v213
  s_nop 1
  v_permlane32_swap_b32 v213, v214
  v_min_f32 v213, v213, v214
  v_mul_f32 v212, s57, v212
  v_mul_f32 v213, s57, v213
  v_fma_f32 v116, v224, s57, -v212
  v_fma_f32 v132, -v224, s57, v213
  v_fma_f32 v117, v225, s57, -v212
  v_fma_f32 v133, -v225, s57, v213
  v_fma_f32 v118, v226, s57, -v212
  v_fma_f32 v134, -v226, s57, v213
  v_fma_f32 v119, v227, s57, -v212
  v_fma_f32 v135, -v227, s57, v213
  v_fma_f32 v120, v228, s57, -v212
  v_fma_f32 v136, -v228, s57, v213
  v_fma_f32 v121, v229, s57, -v212
  v_fma_f32 v137, -v229, s57, v213
  v_fma_f32 v122, v230, s57, -v212
  v_fma_f32 v138, -v230, s57, v213
  v_fma_f32 v123, v231, s57, -v212
  v_fma_f32 v139, -v231, s57, v213
  v_fma_f32 v124, v232, s57, -v212
  v_fma_f32 v140, -v232, s57, v213
  v_fma_f32 v125, v233, s57, -v212
  v_fma_f32 v141, -v233, s57, v213
  v_exp_f32 v116, v116
  v_exp_f32 v132, v132
  v_exp_f32 v117, v117
  v_exp_f32 v133, v133
  v_exp_f32 v118, v118
  v_exp_f32 v134, v134
  v_exp_f32 v119, v119
  v_exp_f32 v135, v135
  v_exp_f32 v120, v120
  v_exp_f32 v136, v136
  v_exp_f32 v121, v121
  v_exp_f32 v137, v137
  v_exp_f32 v122, v122
  v_exp_f32 v138, v138
  v_exp_f32 v123, v123
  v_exp_f32 v139, v139
  v_exp_f32 v124, v124
  v_exp_f32 v140, v140
  v_exp_f32 v125, v125
  v_exp_f32 v141, v141
  v_add_f32 v215, v116, v117
  v_add_f32 v215, v215, v118
  v_add_f32 v215, v215, v119
  v_add_f32 v215, v215, v120
  v_add_f32 v215, v215, v121
  v_add_f32 v215, v215, v122
  v_add_f32 v215, v215, v123
  v_add_f32 v215, v215, v124
  v_add_f32 v215, v215, v125
  v_mov_b32 v214, v215
  s_nop 1
  v_permlane32_swap_b32 v215, v214
  v_add_f32 v215, v215, v214
  v_rcp_f32 v215, v215
  s_nop 0
  v_mul_f32 v116, v116, v215
  v_mul_f32 v117, v117, v215
  v_mul_f32 v118, v118, v215
  v_mul_f32 v119, v119, v215
  v_mul_f32 v120, v120, v215
  v_mul_f32 v121, v121, v215
  v_mul_f32 v122, v122, v215
  v_mul_f32 v123, v123, v215
  v_mul_f32 v124, v124, v215
  v_mul_f32 v125, v125, v215
  v_add_f32 v216, v132, v133
  v_add_f32 v216, v216, v134
  v_add_f32 v216, v216, v135
  v_add_f32 v216, v216, v136
  v_add_f32 v216, v216, v137
  v_add_f32 v216, v216, v138
  v_add_f32 v216, v216, v139
  v_add_f32 v216, v216, v140
  v_add_f32 v216, v216, v141
  v_mov_b32 v214, v216
  s_nop 1
  v_permlane32_swap_b32 v216, v214
  v_add_f32 v216, v216, v214
  v_rcp_f32 v216, v216
  s_nop 0
  v_mul_f32 v132, v132, v216
  v_mul_f32 v133, v133, v216
  v_mul_f32 v134, v134, v216
  v_mul_f32 v135, v135, v216
  v_mul_f32 v136, v136, v216
  v_mul_f32 v137, v137, v216
  v_mul_f32 v138, v138, v216
  v_mul_f32 v139, v139, v216
  v_mul_f32 v140, v140, v216
  v_mul_f32 v141, v141, v216
  v_cvt_pk_bf16_f32 v240, v116, v117
  v_cvt_pk_bf16_f32 v241, v118, v119
  v_cvt_pk_bf16_f32 v242, v120, v121
  v_cvt_pk_bf16_f32 v243, v122, v123
  v_cvt_pk_bf16_f32 v244, v124, v125
  v_mov_b32 v245, 0
  v_cvt_pk_bf16_f32 v246, v132, v133
  v_cvt_pk_bf16_f32 v247, v134, v135
  v_cvt_pk_bf16_f32 v248, v136, v137
  v_cvt_pk_bf16_f32 v249, v138, v139
  v_cvt_pk_bf16_f32 v250, v140, v141
  v_mov_b32 v251, 0
  v_lshlrev_b32 v214, 6, v2
  v_lshl_add_u32 v214, v3, 3, v214
  v_add_u32 v214, s58, v214
  ds_write_b64 v214, v[240:241] offset:0
  ds_write_b64 v214, v[242:243] offset:16
  ds_write_b64 v214, v[244:245] offset:32
  ds_write_b64 v214, v[246:247] offset:2048
  ds_write_b64 v214, v[248:249] offset:2064
  ds_write_b64 v214, v[250:251] offset:2080
  v_bfe_u32 v217, v1, 2, 2
  v_lshl_add_u32 v217, v3, 2, v217
  v_lshlrev_b32 v217, 6, v217
  v_bfe_u32 v218, v1, 4, 1
  v_lshl_add_u32 v217, v218, 5, v217
  v_and_b32 v218, 3, v1
  v_lshl_add_u32 v217, v218, 3, v217
  v_add_u32 v217, s58, v217
  s_waitcnt lgkmcnt(0)
  ds_read_b64_tr_b16 v[172:173], v217 offset:0
  ds_read_b64_tr_b16 v[174:175], v217 offset:512
  ds_read_b64_tr_b16 v[176:177], v217 offset:1024
  ds_read_b64_tr_b16 v[178:179], v217 offset:1536
  ds_read_b64_tr_b16 v[180:181], v217 offset:2048
  ds_read_b64_tr_b16 v[182:183], v217 offset:2560
  ds_read_b64_tr_b16 v[184:185], v217 offset:3072
  ds_read_b64_tr_b16 v[186:187], v217 offset:3584
  s_waitcnt lgkmcnt(0)
  v_mfma_f32_32x32x16_bf16 v[116:131], v[160:163], v[172:175], 0
  v_mfma_f32_32x32x16_bf16 v[116:131], v[164:167], v[176:179], v[116:131]
  v_mfma_f32_32x32x16_bf16 v[132:147], v[160:163], v[180:183], 0
  v_mfma_f32_32x32x16_bf16 v[132:147], v[164:167], v[184:187], v[132:147]
  v_lshlrev_b32 v212, 2, v1
  v_add_u32 v212, s58, v212
  s_nop 7
  ds_write_b32 v212, v116 offset:0
  ds_write_b32 v212, v117 offset:256
  ds_write_b32 v212, v118 offset:512
  ds_write_b32 v212, v119 offset:768
  ds_write_b32 v212, v120 offset:1024
  ds_write_b32 v212, v121 offset:1280
  ds_write_b32 v212, v122 offset:1536
  ds_write_b32 v212, v123 offset:1792
  ds_write_b32 v212, v124 offset:2048
  ds_write_b32 v212, v125 offset:2304
  ds_write_b32 v212, v126 offset:2560
  ds_write_b32 v212, v127 offset:2816
  ds_write_b32 v212, v132 offset:3072
  ds_write_b32 v212, v133 offset:3328
  ds_write_b32 v212, v134 offset:3584
  ds_write_b32 v212, v135 offset:3840
  ds_write_b32 v212, v136 offset:4096
  ds_write_b32 v212, v137 offset:4352
  ds_write_b32 v212, v138 offset:4608
  ds_write_b32 v212, v139 offset:4864
  ds_write_b32 v212, v140 offset:5120
  ds_write_b32 v212, v141 offset:5376
  ds_write_b32 v212, v142 offset:5632
  ds_write_b32 v212, v143 offset:5888
  s_nop 4
  ds_read_b128 v[88:91], v190 offset:0
  ds_read_b64 v[96:97], v193 offset:0
  v_cvt_pk_bf16_f32 v87, v78, v79
  v_mfma_f32_32x32x16_bf16 v[64:79], v[92:95], v[8:11], 0
  v_exp_f32 v48, v48
  v_exp_f32 v49, v49
  v_exp_f32 v50, v50
  v_cvt_pk_bf16_f32 v80, v48, v49
  v_exp_f32 v51, v51
  v_mfma_f32_32x32x16_bf16 v[32:47], v[104:107], v[84:87], v[32:47]
  v_exp_f32 v52, v52
  v_cvt_pk_bf16_f32 v81, v50, v51
  v_exp_f32 v53, v53
  v_exp_f32 v54, v54
  v_cvt_pk_bf16_f32 v82, v52, v53
  v_exp_f32 v55, v55
  v_mfma_f32_32x32x8bf16_1k v[64:79], v[98:99], v[14:15], v[64:79]
  v_exp_f32 v56, v56
  v_cvt_pk_bf16_f32 v83, v54, v55
  v_exp_f32 v57, v57
  v_exp_f32 v58, v58
  v_cvt_pk_bf16_f32 v84, v56, v57
  v_exp_f32 v59, v59
  v_mfma_f32_32x32x16_bf16 v[16:31], v[108:111], v[80:83], v[16:31]
  v_exp_f32 v60, v60
  v_cvt_pk_bf16_f32 v85, v58, v59
  v_exp_f32 v61, v61
  v_exp_f32 v62, v62
  v_cvt_pk_bf16_f32 v86, v60, v61
  v_exp_f32 v63, v63
  s_waitcnt lgkmcnt(0)
  ds_read_b128 v[100:103], v196 offset:0
  v_cvt_pk_bf16_f32 v87, v62, v63
  v_mfma_f32_32x32x16_bf16 v[48:63], v[88:91], v[4:7], 0
  v_exp_f32 v64, v64
  v_exp_f32 v65, v65
  v_exp_f32 v66, v66
  v_cvt_pk_bf16_f32 v80, v64, v65
  v_exp_f32 v67, v67
  v_mfma_f32_32x32x16_bf16 v[16:31], v[112:115], v[84:87], v[16:31]
  ds_read_b128 v[104:107], v196 offset:768
  v_exp_f32 v68, v68
  v_cvt_pk_bf16_f32 v81, v66, v67
  v_exp_f32 v69, v69
  v_exp_f32 v70, v70
  v_cvt_pk_bf16_f32 v82, v68, v69
  v_exp_f32 v71, v71
  v_mfma_f32_32x32x8bf16_1k v[48:63], v[96:97], v[12:13], v[48:63]
  v_exp_f32 v72, v72
  v_cvt_pk_bf16_f32 v83, v70, v71
  v_exp_f32 v73, v73
  v_exp_f32 v74, v74
  v_cvt_pk_bf16_f32 v84, v72, v73
  v_exp_f32 v75, v75
  v_mfma_f32_32x32x16_bf16 v[32:47], v[108:111], v[80:83], v[32:47]
  v_exp_f32 v76, v76
  v_cvt_pk_bf16_f32 v85, v74, v75
  v_exp_f32 v77, v77
  v_exp_f32 v78, v78
  v_cvt_pk_bf16_f32 v86, v76, v77
  v_exp_f32 v79, v79
  s_waitcnt lgkmcnt(0)
  ds_read_b128 v[92:95], v190 offset:3072
  ds_read_b64 v[98:99], v193 offset:3072
  v_cvt_pk_bf16_f32 v87, v78, v79
  v_mfma_f32_32x32x16_bf16 v[64:79], v[88:91], v[8:11], 0
  v_exp_f32 v48, v48
  v_exp_f32 v49, v49
  v_exp_f32 v50, v50
  v_cvt_pk_bf16_f32 v80, v48, v49
  v_exp_f32 v51, v51
  v_mfma_f32_32x32x16_bf16 v[32:47], v[112:115], v[84:87], v[32:47]
  v_exp_f32 v52, v52
  v_cvt_pk_bf16_f32 v81, v50, v51
  v_exp_f32 v53, v53
  v_exp_f32 v54, v54
  v_cvt_pk_bf16_f32 v82, v52, v53
  v_exp_f32 v55, v55
  v_mfma_f32_32x32x8bf16_1k v[64:79], v[96:97], v[14:15], v[64:79]
  v_exp_f32 v56, v56
  v_cvt_pk_bf16_f32 v83, v54, v55
  v_exp_f32 v57, v57
  v_exp_f32 v58, v58
  v_cvt_pk_bf16_f32 v84, v56, v57
  v_exp_f32 v59, v59
  v_mfma_f32_32x32x16_bf16 v[16:31], v[100:103], v[80:83], v[16:31]
  v_exp_f32 v60, v60
  v_cvt_pk_bf16_f32 v85, v58, v59
  v_exp_f32 v61, v61
  v_exp_f32 v62, v62
  v_cvt_pk_bf16_f32 v86, v60, v61
  v_exp_f32 v63, v63
  s_waitcnt lgkmcnt(0)
  ds_read_b128 v[108:111], v196 offset:3072
  v_cvt_pk_bf16_f32 v87, v62, v63
  v_mfma_f32_32x32x16_bf16 v[48:63], v[92:95], v[4:7], 0
  v_exp_f32 v64, v64
  v_exp_f32 v65, v65
  v_exp_f32 v66, v66
  v_cvt_pk_bf16_f32 v80, v64, v65
  v_exp_f32 v67, v67
  v_mfma_f32_32x32x16_bf16 v[16:31], v[104:107], v[84:87], v[16:31]
  ds_read_b128 v[112:115], v196 offset:3840
  v_exp_f32 v68, v68
  v_cvt_pk_bf16_f32 v81, v66, v67
  v_exp_f32 v69, v69
  v_exp_f32 v70, v70
  v_cvt_pk_bf16_f32 v82, v68, v69
  v_exp_f32 v71, v71
  v_mfma_f32_32x32x8bf16_1k v[48:63], v[98:99], v[12:13], v[48:63]
  v_exp_f32 v72, v72
  v_cvt_pk_bf16_f32 v83, v70, v71
  v_exp_f32 v73, v73
  v_exp_f32 v74, v74
  v_cvt_pk_bf16_f32 v84, v72, v73
  v_exp_f32 v75, v75
  v_mfma_f32_32x32x16_bf16 v[32:47], v[100:103], v[80:83], v[32:47]
  v_exp_f32 v76, v76
  v_cvt_pk_bf16_f32 v85, v74, v75
  v_exp_f32 v77, v77
  v_exp_f32 v78, v78
  v_cvt_pk_bf16_f32 v86, v76, v77
  v_exp_f32 v79, v79
  s_waitcnt lgkmcnt(0)
  ds_read_b128 v[88:91], v190 offset:6144
  ds_read_b64 v[96:97], v193 offset:6144
  v_cvt_pk_bf16_f32 v87, v78, v79
  v_mfma_f32_32x32x16_bf16 v[64:79], v[92:95], v[8:11], 0
  v_exp_f32 v48, v48
  v_exp_f32 v49, v49
  v_exp_f32 v50, v50
  v_cvt_pk_bf16_f32 v80, v48, v49
  v_exp_f32 v51, v51
  v_mfma_f32_32x32x16_bf16 v[32:47], v[104:107], v[84:87], v[32:47]
  v_exp_f32 v52, v52
  v_cvt_pk_bf16_f32 v81, v50, v51
  v_exp_f32 v53, v53
  v_exp_f32 v54, v54
  v_cvt_pk_bf16_f32 v82, v52, v53
  v_exp_f32 v55, v55
  v_mfma_f32_32x32x8bf16_1k v[64:79], v[98:99], v[14:15], v[64:79]
  v_exp_f32 v56, v56
  v_cvt_pk_bf16_f32 v83, v54, v55
  v_exp_f32 v57, v57
  v_exp_f32 v58, v58
  v_cvt_pk_bf16_f32 v84, v56, v57
  v_exp_f32 v59, v59
  v_mfma_f32_32x32x16_bf16 v[16:31], v[108:111], v[80:83], v[16:31]
  v_exp_f32 v60, v60
  v_cvt_pk_bf16_f32 v85, v58, v59
  v_exp_f32 v61, v61
  v_exp_f32 v62, v62
  v_cvt_pk_bf16_f32 v86, v60, v61
  v_exp_f32 v63, v63
  s_waitcnt lgkmcnt(0)
  ds_read_b128 v[100:103], v196 offset:6144
  v_cvt_pk_bf16_f32 v87, v62, v63
  v_mfma_f32_32x32x16_bf16 v[48:63], v[88:91], v[4:7], 0
  v_exp_f32 v64, v64
  v_exp_f32 v65, v65
  v_exp_f32 v66, v66
  v_cvt_pk_bf16_f32 v80, v64, v65
  v_exp_f32 v67, v67
  v_mfma_f32_32x32x16_bf16 v[16:31], v[112:115], v[84:87], v[16:31]
  ds_read_b128 v[104:107], v196 offset:6912
  v_exp_f32 v68, v68
  v_cvt_pk_bf16_f32 v81, v66, v67
  v_exp_f32 v69, v69
  v_exp_f32 v70, v70
  v_cvt_pk_bf16_f32 v82, v68, v69
  v_exp_f32 v71, v71
  v_mfma_f32_32x32x8bf16_1k v[48:63], v[96:97], v[12:13], v[48:63]
  v_exp_f32 v72, v72
  v_cvt_pk_bf16_f32 v83, v70, v71
  v_exp_f32 v73, v73
  v_exp_f32 v74, v74
  v_cvt_pk_bf16_f32 v84, v72, v73
  v_exp_f32 v75, v75
  v_mfma_f32_32x32x16_bf16 v[32:47], v[108:111], v[80:83], v[32:47]
  v_exp_f32 v76, v76
  v_cvt_pk_bf16_f32 v85, v74, v75
  v_exp_f32 v77, v77
  v_exp_f32 v78, v78
  v_cvt_pk_bf16_f32 v86, v76, v77
  v_exp_f32 v79, v79
  s_waitcnt lgkmcnt(0)
  ds_read_b128 v[92:95], v190 offset:9216
  ds_read_b64 v[98:99], v193 offset:9216
  v_cvt_pk_bf16_f32 v87, v78, v79
  v_mfma_f32_32x32x16_bf16 v[64:79], v[88:91], v[8:11], 0
  v_exp_f32 v48, v48
  v_exp_f32 v49, v49
  v_exp_f32 v50, v50
  v_cvt_pk_bf16_f32 v80, v48, v49
  v_exp_f32 v51, v51
  v_mfma_f32_32x32x16_bf16 v[32:47], v[112:115], v[84:87], v[32:47]
  v_exp_f32 v52, v52
  v_cvt_pk_bf16_f32 v81, v50, v51
  v_exp_f32 v53, v53
  v_exp_f32 v54, v54
  v_cvt_pk_bf16_f32 v82, v52, v53
  v_exp_f32 v55, v55
  v_mfma_f32_32x32x8bf16_1k v[64:79], v[96:97], v[14:15], v[64:79]
  v_exp_f32 v56, v56
  v_cvt_pk_bf16_f32 v83, v54, v55
  v_exp_f32 v57, v57
  v_exp_f32 v58, v58
  v_cvt_pk_bf16_f32 v84, v56, v57
  v_exp_f32 v59, v59
  v_mfma_f32_32x32x16_bf16 v[16:31], v[100:103], v[80:83], v[16:31]
  v_exp_f32 v60, v60
  v_cvt_pk_bf16_f32 v85, v58, v59
  v_exp_f32 v61, v61
  v_exp_f32 v62, v62
  v_cvt_pk_bf16_f32 v86, v60, v61
  v_exp_f32 v63, v63
  s_waitcnt lgkmcnt(0)
  ds_read_b128 v[108:111], v196 offset:9216
  v_cvt_pk_bf16_f32 v87, v62, v63
  v_mfma_f32_32x32x16_bf16 v[48:63], v[92:95], v[4:7], 0
  v_exp_f32 v64, v64
  v_exp_f32 v65, v65
  v_exp_f32 v66, v66
  v_cvt_pk_bf16_f32 v80, v64, v65
  v_exp_f32 v67, v67
  v_mfma_f32_32x32x16_bf16 v[16:31], v[104:107], v[84:87], v[16:31]
  ds_read_b128 v[112:115], v196 offset:9984
  v_exp_f32 v68, v68
  v_cvt_pk_bf16_f32 v81, v66, v67
  v_exp_f32 v69, v69
  v_exp_f32 v70, v70
  v_cvt_pk_bf16_f32 v82, v68, v69
  v_exp_f32 v71, v71
  v_mfma_f32_32x32x8bf16_1k v[48:63], v[98:99], v[12:13], v[48:63]
  v_exp_f32 v72, v72
  v_cvt_pk_bf16_f32 v83, v70, v71
  v_exp_f32 v73, v73
  v_exp_f32 v74, v74
  v_cvt_pk_bf16_f32 v84, v72, v73
  v_exp_f32 v75, v75
  v_mfma_f32_32x32x16_bf16 v[32:47], v[100:103], v[80:83], v[32:47]
  v_exp_f32 v76, v76
  v_cvt_pk_bf16_f32 v85, v74, v75
  v_exp_f32 v77, v77
  v_exp_f32 v78, v78
  v_cvt_pk_bf16_f32 v86, v76, v77
  v_exp_f32 v79, v79
  s_waitcnt lgkmcnt(0)
  s_waitcnt vmcnt(0)
  s_barrier
  s_add_u32 m0, s18, 110592
  s_add_u32 s23, s11, 98304
  buffer_load_dwordx4 v201, s[4:7], s23 offen offset:0 lds
  buffer_load_dwordx4 v201, s[4:7], s23 offen offset:1024 lds
  buffer_load_dwordx4 v201, s[4:7], s23 offen offset:2048 lds
  v_lshlrev_b32 v212, 2, v1
  s_mul_i32 s57, s8, 768
  s_add_u32 s57, s57, 20480
  v_add_u32 v213, s57, v212
  ds_read_b32 v148, v213 offset:0
  ds_read_b32 v149, v213 offset:6144
  ds_read_b32 v150, v213 offset:12288
  ds_read_b32 v151, v213 offset:18432
  ds_read_b32 v152, v213 offset:24576
  ds_read_b32 v153, v213 offset:30720
  ds_read_b32 v154, v213 offset:36864
  ds_read_b32 v155, v213 offset:43008
  ds_read_b32 v156, v213 offset:256
  ds_read_b32 v157, v213 offset:6400
  ds_read_b32 v158, v213 offset:12544
  ds_read_b32 v159, v213 offset:18688
  ds_read_b32 v160, v213 offset:24832
  ds_read_b32 v161, v213 offset:30976
  ds_read_b32 v162, v213 offset:37120
  ds_read_b32 v163, v213 offset:43264
  ds_read_b32 v164, v213 offset:512
  ds_read_b32 v165, v213 offset:6656
  ds_read_b32 v166, v213 offset:12800
  ds_read_b32 v167, v213 offset:18944
  ds_read_b32 v168, v213 offset:25088
  ds_read_b32 v169, v213 offset:31232
  ds_read_b32 v170, v213 offset:37376
  ds_read_b32 v171, v213 offset:43520
  s_waitcnt lgkmcnt(0)
  v_add_f32 v148, v148, v149
  v_add_f32 v148, v148, v150
  v_add_f32 v148, v148, v151
  v_add_f32 v148, v148, v152
  v_add_f32 v148, v148, v153
  v_add_f32 v148, v148, v154
  v_add_f32 v148, v148, v155
  v_add_f32 v156, v156, v157
  v_add_f32 v156, v156, v158
  v_add_f32 v156, v156, v159
  v_add_f32 v156, v156, v160
  v_add_f32 v156, v156, v161
  v_add_f32 v156, v156, v162
  v_add_f32 v156, v156, v163
  v_add_f32 v164, v164, v165
  v_add_f32 v164, v164, v166
  v_add_f32 v164, v164, v167
  v_add_f32 v164, v164, v168
  v_add_f32 v164, v164, v169
  v_add_f32 v164, v164, v170
  v_add_f32 v164, v164, v171
  s_lshl_b32 s54, s9, 3
  s_add_u32 s54, s54, s10
  s_lshl_b32 s54, s54, 13
  s_add_u32 s54, s54, 26214400
  s_mul_i32 s55, s8, 768
  s_add_u32 s54, s54, s55
  s_cmp_ge_u32 s8, 4
  s_cselect_b32 s55, 1024, 0
  s_add_u32 s54, s54, s55
  buffer_store_dword v148, v212, s[4:7], s54 offen offset:0 sc0 sc1
  buffer_store_dword v156, v212, s[4:7], s54 offen offset:256 sc0 sc1
  buffer_store_dword v164, v212, s[4:7], s54 offen offset:512 sc0 sc1
  ds_read_b128 v[88:91], v188 offset:0
  ds_read_b64 v[96:97], v191 offset:0
  v_cvt_pk_bf16_f32 v87, v78, v79
  v_mfma_f32_32x32x16_bf16 v[64:79], v[92:95], v[8:11], 0
  v_exp_f32 v48, v48
  v_exp_f32 v49, v49
  v_exp_f32 v50, v50
  v_cvt_pk_bf16_f32 v80, v48, v49
  v_exp_f32 v51, v51
  v_mfma_f32_32x32x16_bf16 v[32:47], v[104:107], v[84:87], v[32:47]
  v_exp_f32 v52, v52
  v_cvt_pk_bf16_f32 v81, v50, v51
  v_exp_f32 v53, v53
  v_exp_f32 v54, v54
  v_cvt_pk_bf16_f32 v82, v52, v53
  v_exp_f32 v55, v55
  v_mfma_f32_32x32x8bf16_1k v[64:79], v[98:99], v[14:15], v[64:79]
  v_exp_f32 v56, v56
  v_cvt_pk_bf16_f32 v83, v54, v55
  v_exp_f32 v57, v57
  v_exp_f32 v58, v58
  v_cvt_pk_bf16_f32 v84, v56, v57
  v_exp_f32 v59, v59
  v_mfma_f32_32x32x16_bf16 v[16:31], v[108:111], v[80:83], v[16:31]
  v_exp_f32 v60, v60
  v_cvt_pk_bf16_f32 v85, v58, v59
  v_exp_f32 v61, v61
  v_exp_f32 v62, v62
  v_cvt_pk_bf16_f32 v86, v60, v61
  v_exp_f32 v63, v63
  s_waitcnt lgkmcnt(0)
  ds_read_b128 v[100:103], v194 offset:0
  v_cvt_pk_bf16_f32 v87, v62, v63
  v_mfma_f32_32x32x16_bf16 v[48:63], v[88:91], v[4:7], 0
  v_exp_f32 v64, v64
  v_exp_f32 v65, v65
  v_exp_f32 v66, v66
  v_cvt_pk_bf16_f32 v80, v64, v65
  v_exp_f32 v67, v67
  v_mfma_f32_32x32x16_bf16 v[16:31], v[112:115], v[84:87], v[16:31]
  ds_read_b128 v[104:107], v194 offset:768
  v_exp_f32 v68, v68
  v_cvt_pk_bf16_f32 v81, v66, v67
  v_exp_f32 v69, v69
  v_exp_f32 v70, v70
  v_cvt_pk_bf16_f32 v82, v68, v69
  v_exp_f32 v71, v71
  v_mfma_f32_32x32x8bf16_1k v[48:63], v[96:97], v[12:13], v[48:63]
  v_exp_f32 v72, v72
  v_cvt_pk_bf16_f32 v83, v70, v71
  v_exp_f32 v73, v73
  v_exp_f32 v74, v74
  v_cvt_pk_bf16_f32 v84, v72, v73
  v_exp_f32 v75, v75
  v_mfma_f32_32x32x16_bf16 v[32:47], v[108:111], v[80:83], v[32:47]
  v_exp_f32 v76, v76
  v_cvt_pk_bf16_f32 v85, v74, v75
  v_exp_f32 v77, v77
  v_exp_f32 v78, v78
  v_cvt_pk_bf16_f32 v86, v76, v77
  v_exp_f32 v79, v79
  s_waitcnt lgkmcnt(0)
  ds_read_b128 v[92:95], v188 offset:3072
  ds_read_b64 v[98:99], v191 offset:3072
  v_cvt_pk_bf16_f32 v87, v78, v79
  v_mfma_f32_32x32x16_bf16 v[64:79], v[88:91], v[8:11], 0
  v_exp_f32 v48, v48
  v_exp_f32 v49, v49
  v_exp_f32 v50, v50
  v_cvt_pk_bf16_f32 v80, v48, v49
  v_exp_f32 v51, v51
  v_mfma_f32_32x32x16_bf16 v[32:47], v[112:115], v[84:87], v[32:47]
  v_exp_f32 v52, v52
  v_cvt_pk_bf16_f32 v81, v50, v51
  v_exp_f32 v53, v53
  v_exp_f32 v54, v54
  v_cvt_pk_bf16_f32 v82, v52, v53
  v_exp_f32 v55, v55
  v_mfma_f32_32x32x8bf16_1k v[64:79], v[96:97], v[14:15], v[64:79]
  v_exp_f32 v56, v56
  v_cvt_pk_bf16_f32 v83, v54, v55
  v_exp_f32 v57, v57
  v_exp_f32 v58, v58
  v_cvt_pk_bf16_f32 v84, v56, v57
  v_exp_f32 v59, v59
  v_mfma_f32_32x32x16_bf16 v[16:31], v[100:103], v[80:83], v[16:31]
  v_exp_f32 v60, v60
  v_cvt_pk_bf16_f32 v85, v58, v59
  v_exp_f32 v61, v61
  v_exp_f32 v62, v62
  v_cvt_pk_bf16_f32 v86, v60, v61
  v_exp_f32 v63, v63
  s_waitcnt lgkmcnt(0)
  ds_read_b128 v[108:111], v194 offset:3072
  v_cvt_pk_bf16_f32 v87, v62, v63
  v_mfma_f32_32x32x16_bf16 v[48:63], v[92:95], v[4:7], 0
  v_exp_f32 v64, v64
  v_exp_f32 v65, v65
  v_exp_f32 v66, v66
  v_cvt_pk_bf16_f32 v80, v64, v65
  v_exp_f32 v67, v67
  v_mfma_f32_32x32x16_bf16 v[16:31], v[104:107], v[84:87], v[16:31]
  ds_read_b128 v[112:115], v194 offset:3840
  v_exp_f32 v68, v68
  v_cvt_pk_bf16_f32 v81, v66, v67
  v_exp_f32 v69, v69
  v_exp_f32 v70, v70
  v_cvt_pk_bf16_f32 v82, v68, v69
  v_exp_f32 v71, v71
  v_mfma_f32_32x32x8bf16_1k v[48:63], v[98:99], v[12:13], v[48:63]
  v_exp_f32 v72, v72
  v_cvt_pk_bf16_f32 v83, v70, v71
  v_exp_f32 v73, v73
  v_exp_f32 v74, v74
  v_cvt_pk_bf16_f32 v84, v72, v73
  v_exp_f32 v75, v75
  v_mfma_f32_32x32x16_bf16 v[32:47], v[100:103], v[80:83], v[32:47]
  v_exp_f32 v76, v76
  v_cvt_pk_bf16_f32 v85, v74, v75
  v_exp_f32 v77, v77
  v_exp_f32 v78, v78
  v_cvt_pk_bf16_f32 v86, v76, v77
  v_exp_f32 v79, v79
  s_waitcnt lgkmcnt(0)
  ds_read_b128 v[88:91], v188 offset:6144
  ds_read_b64 v[96:97], v191 offset:6144
  v_cvt_pk_bf16_f32 v87, v78, v79
  v_mfma_f32_32x32x16_bf16 v[64:79], v[92:95], v[8:11], 0
  v_exp_f32 v48, v48
  v_exp_f32 v49, v49
  v_exp_f32 v50, v50
  v_cvt_pk_bf16_f32 v80, v48, v49
  v_exp_f32 v51, v51
  v_mfma_f32_32x32x16_bf16 v[32:47], v[104:107], v[84:87], v[32:47]
  v_exp_f32 v52, v52
  v_cvt_pk_bf16_f32 v81, v50, v51
  v_exp_f32 v53, v53
  v_exp_f32 v54, v54
  v_cvt_pk_bf16_f32 v82, v52, v53
  v_exp_f32 v55, v55
  v_mfma_f32_32x32x8bf16_1k v[64:79], v[98:99], v[14:15], v[64:79]
  v_exp_f32 v56, v56
  v_cvt_pk_bf16_f32 v83, v54, v55
  v_exp_f32 v57, v57
  v_exp_f32 v58, v58
  v_cvt_pk_bf16_f32 v84, v56, v57
  v_exp_f32 v59, v59
  v_mfma_f32_32x32x16_bf16 v[16:31], v[108:111], v[80:83], v[16:31]
  v_exp_f32 v60, v60
  v_cvt_pk_bf16_f32 v85, v58, v59
  v_exp_f32 v61, v61
  v_exp_f32 v62, v62
  v_cvt_pk_bf16_f32 v86, v60, v61
  v_exp_f32 v63, v63
  s_waitcnt lgkmcnt(0)
  ds_read_b128 v[100:103], v194 offset:6144
  v_cvt_pk_bf16_f32 v87, v62, v63
  v_mfma_f32_32x32x16_bf16 v[48:63], v[88:91], v[4:7], 0
  v_exp_f32 v64, v64
  v_exp_f32 v65, v65
  v_exp_f32 v66, v66
  v_cvt_pk_bf16_f32 v80, v64, v65
  v_exp_f32 v67, v67
  v_mfma_f32_32x32x16_bf16 v[16:31], v[112:115], v[84:87], v[16:31]
  ds_read_b128 v[104:107], v194 offset:6912
  v_exp_f32 v68, v68
  v_cvt_pk_bf16_f32 v81, v66, v67
  v_exp_f32 v69, v69
  v_exp_f32 v70, v70
  v_cvt_pk_bf16_f32 v82, v68, v69
  v_exp_f32 v71, v71
  v_mfma_f32_32x32x8bf16_1k v[48:63], v[96:97], v[12:13], v[48:63]
  v_exp_f32 v72, v72
  v_cvt_pk_bf16_f32 v83, v70, v71
  v_exp_f32 v73, v73
  v_exp_f32 v74, v74
  v_cvt_pk_bf16_f32 v84, v72, v73
  v_exp_f32 v75, v75
  v_mfma_f32_32x32x16_bf16 v[32:47], v[108:111], v[80:83], v[32:47]
  v_exp_f32 v76, v76
  v_cvt_pk_bf16_f32 v85, v74, v75
  v_exp_f32 v77, v77
  v_exp_f32 v78, v78
  v_cvt_pk_bf16_f32 v86, v76, v77
  v_exp_f32 v79, v79
  s_waitcnt lgkmcnt(0)
  ds_read_b128 v[92:95], v188 offset:9216
  ds_read_b64 v[98:99], v191 offset:9216
  v_cvt_pk_bf16_f32 v87, v78, v79
  v_mfma_f32_32x32x16_bf16 v[64:79], v[88:91], v[8:11], 0
  v_exp_f32 v48, v48
  v_exp_f32 v49, v49
  v_exp_f32 v50, v50
  v_cvt_pk_bf16_f32 v80, v48, v49
  v_exp_f32 v51, v51
  v_mfma_f32_32x32x16_bf16 v[32:47], v[112:115], v[84:87], v[32:47]
  v_exp_f32 v52, v52
  v_cvt_pk_bf16_f32 v81, v50, v51
  v_exp_f32 v53, v53
  v_exp_f32 v54, v54
  v_cvt_pk_bf16_f32 v82, v52, v53
  v_exp_f32 v55, v55
  v_mfma_f32_32x32x8bf16_1k v[64:79], v[96:97], v[14:15], v[64:79]
  v_exp_f32 v56, v56
  v_cvt_pk_bf16_f32 v83, v54, v55
  v_exp_f32 v57, v57
  v_exp_f32 v58, v58
  v_cvt_pk_bf16_f32 v84, v56, v57
  v_exp_f32 v59, v59
  v_mfma_f32_32x32x16_bf16 v[16:31], v[100:103], v[80:83], v[16:31]
  v_exp_f32 v60, v60
  v_cvt_pk_bf16_f32 v85, v58, v59
  v_exp_f32 v61, v61
  v_exp_f32 v62, v62
  v_cvt_pk_bf16_f32 v86, v60, v61
  v_exp_f32 v63, v63
  s_waitcnt lgkmcnt(0)
  ds_read_b128 v[108:111], v194 offset:9216
  v_cvt_pk_bf16_f32 v87, v62, v63
  v_mfma_f32_32x32x16_bf16 v[48:63], v[92:95], v[4:7], 0
  v_exp_f32 v64, v64
  v_exp_f32 v65, v65
  v_exp_f32 v66, v66
  v_cvt_pk_bf16_f32 v80, v64, v65
  v_exp_f32 v67, v67
  v_mfma_f32_32x32x16_bf16 v[16:31], v[104:107], v[84:87], v[16:31]
  ds_read_b128 v[112:115], v194 offset:9984
  v_exp_f32 v68, v68
  v_cvt_pk_bf16_f32 v81, v66, v67
  v_exp_f32 v69, v69
  v_exp_f32 v70, v70
  v_cvt_pk_bf16_f32 v82, v68, v69
  v_exp_f32 v71, v71
  v_mfma_f32_32x32x8bf16_1k v[48:63], v[98:99], v[12:13], v[48:63]
  v_exp_f32 v72, v72
  v_cvt_pk_bf16_f32 v83, v70, v71
  v_exp_f32 v73, v73
  v_exp_f32 v74, v74
  v_cvt_pk_bf16_f32 v84, v72, v73
  v_exp_f32 v75, v75
  v_mfma_f32_32x32x16_bf16 v[32:47], v[100:103], v[80:83], v[32:47]
  v_exp_f32 v76, v76
  v_cvt_pk_bf16_f32 v85, v74, v75
  v_exp_f32 v77, v77
  v_exp_f32 v78, v78
  v_cvt_pk_bf16_f32 v86, v76, v77
  v_exp_f32 v79, v79
  s_waitcnt lgkmcnt(0)
  s_waitcnt vmcnt(3)
  s_waitcnt vmcnt(0)
  s_barrier
  s_add_u32 m0, s18, 135168
  s_add_u32 s23, s11, 122880
  buffer_load_dwordx4 v201, s[4:7], s23 offen offset:0 lds
  buffer_load_dwordx4 v201, s[4:7], s23 offen offset:1024 lds
  buffer_load_dwordx4 v201, s[4:7], s23 offen offset:2048 lds
  s_cmp_lg_u32 s8, 0
  s_cbranch_scc1 L_att_kernel_nosig
  s_lshl_b32 s54, s9, 7
  s_lshl_b32 s55, s10, 2
  s_add_u32 s54, s54, s55
  s_add_u32 s54, s54, 28311552
  v_mov_b32 v212, 0
  v_mov_b32 v213, 1
  s_mov_b64 exec, 1
  buffer_store_dword v213, v212, s[4:7], s54 offen sc0 sc1
  s_mov_b64 exec, -1
L_att_kernel_nosig:
  ds_read_b128 v[88:91], v189 offset:0
  ds_read_b64 v[96:97], v192 offset:0
  v_cvt_pk_bf16_f32 v87, v78, v79
  v_mfma_f32_32x32x16_bf16 v[64:79], v[92:95], v[8:11], 0
  v_exp_f32 v48, v48
  v_exp_f32 v49, v49
  v_exp_f32 v50, v50
  v_cvt_pk_bf16_f32 v80, v48, v49
  v_exp_f32 v51, v51
  v_mfma_f32_32x32x16_bf16 v[32:47], v[104:107], v[84:87], v[32:47]
  v_exp_f32 v52, v52
  v_cvt_pk_bf16_f32 v81, v50, v51
  v_exp_f32 v53, v53
  v_exp_f32 v54, v54
  v_cvt_pk_bf16_f32 v82, v52, v53
  v_exp_f32 v55, v55
  v_mfma_f32_32x32x8bf16_1k v[64:79], v[98:99], v[14:15], v[64:79]
  v_exp_f32 v56, v56
  v_cvt_pk_bf16_f32 v83, v54, v55
  v_exp_f32 v57, v57
  v_exp_f32 v58, v58
  v_cvt_pk_bf16_f32 v84, v56, v57
  v_exp_f32 v59, v59
  v_mfma_f32_32x32x16_bf16 v[16:31], v[108:111], v[80:83], v[16:31]
  v_exp_f32 v60, v60
  v_cvt_pk_bf16_f32 v85, v58, v59
  v_exp_f32 v61, v61
  v_exp_f32 v62, v62
  v_cvt_pk_bf16_f32 v86, v60, v61
  v_exp_f32 v63, v63
  s_waitcnt lgkmcnt(0)
  ds_read_b128 v[100:103], v195 offset:0
  v_cvt_pk_bf16_f32 v87, v62, v63
  v_mfma_f32_32x32x16_bf16 v[48:63], v[88:91], v[4:7], 0
  v_exp_f32 v64, v64
  v_exp_f32 v65, v65
  v_exp_f32 v66, v66
  v_cvt_pk_bf16_f32 v80, v64, v65
  v_exp_f32 v67, v67
  v_mfma_f32_32x32x16_bf16 v[16:31], v[112:115], v[84:87], v[16:31]
  ds_read_b128 v[104:107], v195 offset:768
  v_exp_f32 v68, v68
  v_cvt_pk_bf16_f32 v81, v66, v67
  v_exp_f32 v69, v69
  v_exp_f32 v70, v70
  v_cvt_pk_bf16_f32 v82, v68, v69
  v_exp_f32 v71, v71
  v_mfma_f32_32x32x8bf16_1k v[48:63], v[96:97], v[12:13], v[48:63]
  v_exp_f32 v72, v72
  v_cvt_pk_bf16_f32 v83, v70, v71
  v_exp_f32 v73, v73
  v_exp_f32 v74, v74
  v_cvt_pk_bf16_f32 v84, v72, v73
  v_exp_f32 v75, v75
  v_mfma_f32_32x32x16_bf16 v[32:47], v[108:111], v[80:83], v[32:47]
  v_exp_f32 v76, v76
  v_cvt_pk_bf16_f32 v85, v74, v75
  v_exp_f32 v77, v77
  v_exp_f32 v78, v78
  v_cvt_pk_bf16_f32 v86, v76, v77
  v_exp_f32 v79, v79
  s_waitcnt lgkmcnt(0)
  ds_read_b128 v[92:95], v189 offset:3072
  ds_read_b64 v[98:99], v192 offset:3072
  v_cvt_pk_bf16_f32 v87, v78, v79
  v_mfma_f32_32x32x16_bf16 v[64:79], v[88:91], v[8:11], 0
  v_exp_f32 v48, v48
  v_exp_f32 v49, v49
  v_exp_f32 v50, v50
  v_cvt_pk_bf16_f32 v80, v48, v49
  v_exp_f32 v51, v51
  v_mfma_f32_32x32x16_bf16 v[32:47], v[112:115], v[84:87], v[32:47]
  v_exp_f32 v52, v52
  v_cvt_pk_bf16_f32 v81, v50, v51
  v_exp_f32 v53, v53
  v_exp_f32 v54, v54
  v_cvt_pk_bf16_f32 v82, v52, v53
  v_exp_f32 v55, v55
  v_mfma_f32_32x32x8bf16_1k v[64:79], v[96:97], v[14:15], v[64:79]
  v_exp_f32 v56, v56
  v_cvt_pk_bf16_f32 v83, v54, v55
  v_exp_f32 v57, v57
  v_exp_f32 v58, v58
  v_cvt_pk_bf16_f32 v84, v56, v57
  v_exp_f32 v59, v59
  v_mfma_f32_32x32x16_bf16 v[16:31], v[100:103], v[80:83], v[16:31]
  v_exp_f32 v60, v60
  v_cvt_pk_bf16_f32 v85, v58, v59
  v_exp_f32 v61, v61
  v_exp_f32 v62, v62
  v_cvt_pk_bf16_f32 v86, v60, v61
  v_exp_f32 v63, v63
  s_waitcnt lgkmcnt(0)
  ds_read_b128 v[108:111], v195 offset:3072
  v_cvt_pk_bf16_f32 v87, v62, v63
  v_mfma_f32_32x32x16_bf16 v[48:63], v[92:95], v[4:7], 0
  v_exp_f32 v64, v64
  v_exp_f32 v65, v65
  v_exp_f32 v66, v66
  v_cvt_pk_bf16_f32 v80, v64, v65
  v_exp_f32 v67, v67
  v_mfma_f32_32x32x16_bf16 v[16:31], v[104:107], v[84:87], v[16:31]
  ds_read_b128 v[112:115], v195 offset:3840
  v_exp_f32 v68, v68
  v_cvt_pk_bf16_f32 v81, v66, v67
  v_exp_f32 v69, v69
  v_exp_f32 v70, v70
  v_cvt_pk_bf16_f32 v82, v68, v69
  v_exp_f32 v71, v71
  v_mfma_f32_32x32x8bf16_1k v[48:63], v[98:99], v[12:13], v[48:63]
  v_exp_f32 v72, v72
  v_cvt_pk_bf16_f32 v83, v70, v71
  v_exp_f32 v73, v73
  v_exp_f32 v74, v74
  v_cvt_pk_bf16_f32 v84, v72, v73
  v_exp_f32 v75, v75
  v_mfma_f32_32x32x16_bf16 v[32:47], v[100:103], v[80:83], v[32:47]
  v_exp_f32 v76, v76
  v_cvt_pk_bf16_f32 v85, v74, v75
  v_exp_f32 v77, v77
  v_exp_f32 v78, v78
  v_cvt_pk_bf16_f32 v86, v76, v77
  v_exp_f32 v79, v79
  s_waitcnt lgkmcnt(0)
  ds_read_b128 v[88:91], v189 offset:6144
  ds_read_b64 v[96:97], v192 offset:6144
  v_cvt_pk_bf16_f32 v87, v78, v79
  v_mfma_f32_32x32x16_bf16 v[64:79], v[92:95], v[8:11], 0
  v_exp_f32 v48, v48
  v_exp_f32 v49, v49
  v_exp_f32 v50, v50
  v_cvt_pk_bf16_f32 v80, v48, v49
  v_exp_f32 v51, v51
  v_mfma_f32_32x32x16_bf16 v[32:47], v[104:107], v[84:87], v[32:47]
  v_exp_f32 v52, v52
  v_cvt_pk_bf16_f32 v81, v50, v51
  v_exp_f32 v53, v53
  v_exp_f32 v54, v54
  v_cvt_pk_bf16_f32 v82, v52, v53
  v_exp_f32 v55, v55
  v_mfma_f32_32x32x8bf16_1k v[64:79], v[98:99], v[14:15], v[64:79]
  v_exp_f32 v56, v56
  v_cvt_pk_bf16_f32 v83, v54, v55
  v_exp_f32 v57, v57
  v_exp_f32 v58, v58
  v_cvt_pk_bf16_f32 v84, v56, v57
  v_exp_f32 v59, v59
  v_mfma_f32_32x32x16_bf16 v[16:31], v[108:111], v[80:83], v[16:31]
  v_exp_f32 v60, v60
  v_cvt_pk_bf16_f32 v85, v58, v59
  v_exp_f32 v61, v61
  v_exp_f32 v62, v62
  v_cvt_pk_bf16_f32 v86, v60, v61
  v_exp_f32 v63, v63
  s_waitcnt lgkmcnt(0)
  ds_read_b128 v[100:103], v195 offset:6144
  v_cvt_pk_bf16_f32 v87, v62, v63
  v_mfma_f32_32x32x16_bf16 v[48:63], v[88:91], v[4:7], 0
  v_exp_f32 v64, v64
  v_exp_f32 v65, v65
  v_exp_f32 v66, v66
  v_cvt_pk_bf16_f32 v80, v64, v65
  v_exp_f32 v67, v67
  v_mfma_f32_32x32x16_bf16 v[16:31], v[112:115], v[84:87], v[16:31]
  ds_read_b128 v[104:107], v195 offset:6912
  v_exp_f32 v68, v68
  v_cvt_pk_bf16_f32 v81, v66, v67
  v_exp_f32 v69, v69
  v_exp_f32 v70, v70
  v_cvt_pk_bf16_f32 v82, v68, v69
  v_exp_f32 v71, v71
  v_mfma_f32_32x32x8bf16_1k v[48:63], v[96:97], v[12:13], v[48:63]
  v_exp_f32 v72, v72
  v_cvt_pk_bf16_f32 v83, v70, v71
  v_exp_f32 v73, v73
  v_exp_f32 v74, v74
  v_cvt_pk_bf16_f32 v84, v72, v73
  v_exp_f32 v75, v75
  v_mfma_f32_32x32x16_bf16 v[32:47], v[108:111], v[80:83], v[32:47]
  v_exp_f32 v76, v76
  v_cvt_pk_bf16_f32 v85, v74, v75
  v_exp_f32 v77, v77
  v_exp_f32 v78, v78
  v_cvt_pk_bf16_f32 v86, v76, v77
  v_exp_f32 v79, v79
  s_waitcnt lgkmcnt(0)
  ds_read_b128 v[92:95], v189 offset:9216
  ds_read_b64 v[98:99], v192 offset:9216
  v_cvt_pk_bf16_f32 v87, v78, v79
  v_mfma_f32_32x32x16_bf16 v[64:79], v[88:91], v[8:11], 0
  v_exp_f32 v48, v48
  v_exp_f32 v49, v49
  v_exp_f32 v50, v50
  v_cvt_pk_bf16_f32 v80, v48, v49
  v_exp_f32 v51, v51
  v_mfma_f32_32x32x16_bf16 v[32:47], v[112:115], v[84:87], v[32:47]
  v_exp_f32 v52, v52
  v_cvt_pk_bf16_f32 v81, v50, v51
  v_exp_f32 v53, v53
  v_exp_f32 v54, v54
  v_cvt_pk_bf16_f32 v82, v52, v53
  v_exp_f32 v55, v55
  v_mfma_f32_32x32x8bf16_1k v[64:79], v[96:97], v[14:15], v[64:79]
  v_exp_f32 v56, v56
  v_cvt_pk_bf16_f32 v83, v54, v55
  v_exp_f32 v57, v57
  v_exp_f32 v58, v58
  v_cvt_pk_bf16_f32 v84, v56, v57
  v_exp_f32 v59, v59
  v_mfma_f32_32x32x16_bf16 v[16:31], v[100:103], v[80:83], v[16:31]
  v_exp_f32 v60, v60
  v_cvt_pk_bf16_f32 v85, v58, v59
  v_exp_f32 v61, v61
  v_exp_f32 v62, v62
  v_cvt_pk_bf16_f32 v86, v60, v61
  v_exp_f32 v63, v63
  s_waitcnt lgkmcnt(0)
  ds_read_b128 v[108:111], v195 offset:9216
  v_cvt_pk_bf16_f32 v87, v62, v63
  v_mfma_f32_32x32x16_bf16 v[48:63], v[92:95], v[4:7], 0
  v_exp_f32 v64, v64
  v_exp_f32 v65, v65
  v_exp_f32 v66, v66
  v_cvt_pk_bf16_f32 v80, v64, v65
  v_exp_f32 v67, v67
  v_mfma_f32_32x32x16_bf16 v[16:31], v[104:107], v[84:87], v[16:31]
  ds_read_b128 v[112:115], v195 offset:9984
  v_exp_f32 v68, v68
  v_cvt_pk_bf16_f32 v81, v66, v67
  v_exp_f32 v69, v69
  v_exp_f32 v70, v70
  v_cvt_pk_bf16_f32 v82, v68, v69
  v_exp_f32 v71, v71
  v_mfma_f32_32x32x8bf16_1k v[48:63], v[98:99], v[12:13], v[48:63]
  v_exp_f32 v72, v72
  v_cvt_pk_bf16_f32 v83, v70, v71
  v_exp_f32 v73, v73
  v_exp_f32 v74, v74
  v_cvt_pk_bf16_f32 v84, v72, v73
  v_exp_f32 v75, v75
  v_mfma_f32_32x32x16_bf16 v[32:47], v[100:103], v[80:83], v[32:47]
  v_exp_f32 v76, v76
  v_cvt_pk_bf16_f32 v85, v74, v75
  v_exp_f32 v77, v77
  v_exp_f32 v78, v78
  v_cvt_pk_bf16_f32 v86, v76, v77
  v_exp_f32 v79, v79
  s_waitcnt lgkmcnt(0)
  s_waitcnt vmcnt(0)
  s_barrier
  s_add_u32 m0, s18, 86016
  s_add_u32 s23, s11, 147456
  buffer_load_dwordx4 v201, s[4:7], s23 offen offset:0 lds
  buffer_load_dwordx4 v201, s[4:7], s23 offen offset:1024 lds
  buffer_load_dwordx4 v201, s[4:7], s23 offen offset:2048 lds
  ds_read_b128 v[88:91], v190 offset:0
  ds_read_b64 v[96:97], v193 offset:0
  v_cvt_pk_bf16_f32 v87, v78, v79
  v_mfma_f32_32x32x16_bf16 v[64:79], v[92:95], v[8:11], 0
  v_exp_f32 v48, v48
  v_exp_f32 v49, v49
  v_exp_f32 v50, v50
  v_cvt_pk_bf16_f32 v80, v48, v49
  v_exp_f32 v51, v51
  v_mfma_f32_32x32x16_bf16 v[32:47], v[104:107], v[84:87], v[32:47]
  v_exp_f32 v52, v52
  v_cvt_pk_bf16_f32 v81, v50, v51
  v_exp_f32 v53, v53
  v_exp_f32 v54, v54
  v_cvt_pk_bf16_f32 v82, v52, v53
  v_exp_f32 v55, v55
  v_mfma_f32_32x32x8bf16_1k v[64:79], v[98:99], v[14:15], v[64:79]
  v_exp_f32 v56, v56
  v_cvt_pk_bf16_f32 v83, v54, v55
  v_exp_f32 v57, v57
  v_exp_f32 v58, v58
  v_cvt_pk_bf16_f32 v84, v56, v57
  v_exp_f32 v59, v59
  v_mfma_f32_32x32x16_bf16 v[16:31], v[108:111], v[80:83], v[16:31]
  v_exp_f32 v60, v60
  v_cvt_pk_bf16_f32 v85, v58, v59
  v_exp_f32 v61, v61
  v_exp_f32 v62, v62
  v_cvt_pk_bf16_f32 v86, v60, v61
  v_exp_f32 v63, v63
  s_waitcnt lgkmcnt(0)
  ds_read_b128 v[100:103], v196 offset:0
  v_cvt_pk_bf16_f32 v87, v62, v63
  v_mfma_f32_32x32x16_bf16 v[48:63], v[88:91], v[4:7], 0
  v_exp_f32 v64, v64
  v_exp_f32 v65, v65
  v_exp_f32 v66, v66
  v_cvt_pk_bf16_f32 v80, v64, v65
  v_exp_f32 v67, v67
  v_mfma_f32_32x32x16_bf16 v[16:31], v[112:115], v[84:87], v[16:31]
  ds_read_b128 v[104:107], v196 offset:768
  v_exp_f32 v68, v68
  v_cvt_pk_bf16_f32 v81, v66, v67
  v_exp_f32 v69, v69
  v_exp_f32 v70, v70
  v_cvt_pk_bf16_f32 v82, v68, v69
  v_exp_f32 v71, v71
  v_mfma_f32_32x32x8bf16_1k v[48:63], v[96:97], v[12:13], v[48:63]
  v_exp_f32 v72, v72
  v_cvt_pk_bf16_f32 v83, v70, v71
  v_exp_f32 v73, v73
  v_exp_f32 v74, v74
  v_cvt_pk_bf16_f32 v84, v72, v73
  v_exp_f32 v75, v75
  v_mfma_f32_32x32x16_bf16 v[32:47], v[108:111], v[80:83], v[32:47]
  v_exp_f32 v76, v76
  v_cvt_pk_bf16_f32 v85, v74, v75
  v_exp_f32 v77, v77
  v_exp_f32 v78, v78
  v_cvt_pk_bf16_f32 v86, v76, v77
  v_exp_f32 v79, v79
  s_waitcnt lgkmcnt(0)
  s_mov_b32 s56, 0
  s_cmp_lg_u32 s56, 0
  s_cbranch_scc1 L_att_kernel_pdonef
  s_lshl_b32 s54, s9, 7
  s_add_u32 s54, s54, 28311552
  v_and_b32 v212, 7, v1
  v_lshlrev_b32 v212, 2, v212
L_att_kernel_pollf:
  buffer_load_dword v213, v212, s[4:7], s54 offen sc0 sc1
  s_waitcnt vmcnt(0)
  v_cmp_ne_u32 vcc, 1, v213
  s_mov_b32 s56, 0
  s_nop 0
  s_cmp_eq_u64 vcc, 0
  s_cbranch_scc1 L_att_kernel_polledf
  s_sleep 32
  s_branch L_att_kernel_pollf
L_att_kernel_polledf:
  s_mov_b32 s56, 1
  v_lshlrev_b32 v212, 4, v0
  s_lshl_b32 s54, s9, 16
  s_add_u32 s54, s54, 26214400
  s_add_u32 s55, s54, 0
  buffer_load_dwordx4 v[116:119], v212, s[4:7], s55 offen sc0 sc1
  s_add_u32 s55, s54, 8192
  buffer_load_dwordx4 v[120:123], v212, s[4:7], s55 offen sc0 sc1
  s_add_u32 s55, s54, 16384
  buffer_load_dwordx4 v[124:127], v212, s[4:7], s55 offen sc0 sc1
  s_add_u32 s55, s54, 24576
  buffer_load_dwordx4 v[128:131], v212, s[4:7], s55 offen sc0 sc1
  s_add_u32 s55, s54, 32768
  buffer_load_dwordx4 v[132:135], v212, s[4:7], s55 offen sc0 sc1
  s_add_u32 s55, s54, 40960
  buffer_load_dwordx4 v[136:139], v212, s[4:7], s55 offen sc0 sc1
  s_add_u32 s55, s54, 49152
  buffer_load_dwordx4 v[140:143], v212, s[4:7], s55 offen sc0 sc1
  s_add_u32 s55, s54, 57344
  buffer_load_dwordx4 v[144:147], v212, s[4:7], s55 offen sc0 sc1
L_att_kernel_pdonef:
  ds_read_b128 v[92:95], v190 offset:3072
  ds_read_b64 v[98:99], v193 offset:3072
  v_cvt_pk_bf16_f32 v87, v78, v79
  v_mfma_f32_32x32x16_bf16 v[64:79], v[88:91], v[8:11], 0
  v_exp_f32 v48, v48
  v_exp_f32 v49, v49
  v_exp_f32 v50, v50
  v_cvt_pk_bf16_f32 v80, v48, v49
  v_exp_f32 v51, v51
  v_mfma_f32_32x32x16_bf16 v[32:47], v[112:115], v[84:87], v[32:47]
  v_exp_f32 v52, v52
  v_cvt_pk_bf16_f32 v81, v50, v51
  v_exp_f32 v53, v53
  v_exp_f32 v54, v54
  v_cvt_pk_bf16_f32 v82, v52, v53
  v_exp_f32 v55, v55
  v_mfma_f32_32x32x8bf16_1k v[64:79], v[96:97], v[14:15], v[64:79]
  v_exp_f32 v56, v56
  v_cvt_pk_bf16_f32 v83, v54, v55
  v_exp_f32 v57, v57
  v_exp_f32 v58, v58
  v_cvt_pk_bf16_f32 v84, v56, v57
  v_exp_f32 v59, v59
  v_mfma_f32_32x32x16_bf16 v[16:31], v[100:103], v[80:83], v[16:31]
  v_exp_f32 v60, v60
  v_cvt_pk_bf16_f32 v85, v58, v59
  v_exp_f32 v61, v61
  v_exp_f32 v62, v62
  v_cvt_pk_bf16_f32 v86, v60, v61
  v_exp_f32 v63, v63
  s_waitcnt lgkmcnt(0)
  ds_read_b128 v[108:111], v196 offset:3072
  v_cvt_pk_bf16_f32 v87, v62, v63
  v_mfma_f32_32x32x16_bf16 v[48:63], v[92:95], v[4:7], 0
  v_exp_f32 v64, v64
  v_exp_f32 v65, v65
  v_exp_f32 v66, v66
  v_cvt_pk_bf16_f32 v80, v64, v65
  v_exp_f32 v67, v67
  v_mfma_f32_32x32x16_bf16 v[16:31], v[104:107], v[84:87], v[16:31]
  ds_read_b128 v[112:115], v196 offset:3840
  v_exp_f32 v68, v68
  v_cvt_pk_bf16_f32 v81, v66, v67
  v_exp_f32 v69, v69
  v_exp_f32 v70, v70
  v_cvt_pk_bf16_f32 v82, v68, v69
  v_exp_f32 v71, v71
  v_mfma_f32_32x32x8bf16_1k v[48:63], v[98:99], v[12:13], v[48:63]
  v_exp_f32 v72, v72
  v_cvt_pk_bf16_f32 v83, v70, v71
  v_exp_f32 v73, v73
  v_exp_f32 v74, v74
  v_cvt_pk_bf16_f32 v84, v72, v73
  v_exp_f32 v75, v75
  v_mfma_f32_32x32x16_bf16 v[32:47], v[100:103], v[80:83], v[32:47]
  v_exp_f32 v76, v76
  v_cvt_pk_bf16_f32 v85, v74, v75
  v_exp_f32 v77, v77
  v_exp_f32 v78, v78
  v_cvt_pk_bf16_f32 v86, v76, v77
  v_exp_f32 v79, v79
  s_waitcnt lgkmcnt(0)
  ds_read_b128 v[88:91], v190 offset:6144
  ds_read_b64 v[96:97], v193 offset:6144
  v_cvt_pk_bf16_f32 v87, v78, v79
  v_mfma_f32_32x32x16_bf16 v[64:79], v[92:95], v[8:11], 0
  v_exp_f32 v48, v48
  v_exp_f32 v49, v49
  v_exp_f32 v50, v50
  v_cvt_pk_bf16_f32 v80, v48, v49
  v_exp_f32 v51, v51
  v_mfma_f32_32x32x16_bf16 v[32:47], v[104:107], v[84:87], v[32:47]
  v_exp_f32 v52, v52
  v_cvt_pk_bf16_f32 v81, v50, v51
  v_exp_f32 v53, v53
  v_exp_f32 v54, v54
  v_cvt_pk_bf16_f32 v82, v52, v53
  v_exp_f32 v55, v55
  v_mfma_f32_32x32x8bf16_1k v[64:79], v[98:99], v[14:15], v[64:79]
  v_exp_f32 v56, v56
  v_cvt_pk_bf16_f32 v83, v54, v55
  v_exp_f32 v57, v57
  v_exp_f32 v58, v58
  v_cvt_pk_bf16_f32 v84, v56, v57
  v_exp_f32 v59, v59
  v_mfma_f32_32x32x16_bf16 v[16:31], v[108:111], v[80:83], v[16:31]
  v_exp_f32 v60, v60
  v_cvt_pk_bf16_f32 v85, v58, v59
  v_exp_f32 v61, v61
  v_exp_f32 v62, v62
  v_cvt_pk_bf16_f32 v86, v60, v61
  v_exp_f32 v63, v63
  s_waitcnt lgkmcnt(0)
  ds_read_b128 v[100:103], v196 offset:6144
  v_cvt_pk_bf16_f32 v87, v62, v63
  v_mfma_f32_32x32x16_bf16 v[48:63], v[88:91], v[4:7], 0
  v_exp_f32 v64, v64
  v_exp_f32 v65, v65
  v_exp_f32 v66, v66
  v_cvt_pk_bf16_f32 v80, v64, v65
  v_exp_f32 v67, v67
  v_mfma_f32_32x32x16_bf16 v[16:31], v[112:115], v[84:87], v[16:31]
  ds_read_b128 v[104:107], v196 offset:6912
  v_exp_f32 v68, v68
  v_cvt_pk_bf16_f32 v81, v66, v67
  v_exp_f32 v69, v69
  v_exp_f32 v70, v70
  v_cvt_pk_bf16_f32 v82, v68, v69
  v_exp_f32 v71, v71
  v_mfma_f32_32x32x8bf16_1k v[48:63], v[96:97], v[12:13], v[48:63]
  v_exp_f32 v72, v72
  v_cvt_pk_bf16_f32 v83, v70, v71
  v_exp_f32 v73, v73
  v_exp_f32 v74, v74
  v_cvt_pk_bf16_f32 v84, v72, v73
  v_exp_f32 v75, v75
  v_mfma_f32_32x32x16_bf16 v[32:47], v[108:111], v[80:83], v[32:47]
  v_exp_f32 v76, v76
  v_cvt_pk_bf16_f32 v85, v74, v75
  v_exp_f32 v77, v77
  v_exp_f32 v78, v78
  v_cvt_pk_bf16_f32 v86, v76, v77
  v_exp_f32 v79, v79
  s_waitcnt lgkmcnt(0)
  ds_read_b128 v[92:95], v190 offset:9216
  ds_read_b64 v[98:99], v193 offset:9216
  v_cvt_pk_bf16_f32 v87, v78, v79
  v_mfma_f32_32x32x16_bf16 v[64:79], v[88:91], v[8:11], 0
  v_exp_f32 v48, v48
  v_exp_f32 v49, v49
  v_exp_f32 v50, v50
  v_cvt_pk_bf16_f32 v80, v48, v49
  v_exp_f32 v51, v51
  v_mfma_f32_32x32x16_bf16 v[32:47], v[112:115], v[84:87], v[32:47]
  v_exp_f32 v52, v52
  v_cvt_pk_bf16_f32 v81, v50, v51
  v_exp_f32 v53, v53
  v_exp_f32 v54, v54
  v_cvt_pk_bf16_f32 v82, v52, v53
  v_exp_f32 v55, v55
  v_mfma_f32_32x32x8bf16_1k v[64:79], v[96:97], v[14:15], v[64:79]
  v_exp_f32 v56, v56
  v_cvt_pk_bf16_f32 v83, v54, v55
  v_exp_f32 v57, v57
  v_exp_f32 v58, v58
  v_cvt_pk_bf16_f32 v84, v56, v57
  v_exp_f32 v59, v59
  v_mfma_f32_32x32x16_bf16 v[16:31], v[100:103], v[80:83], v[16:31]
  v_exp_f32 v60, v60
  v_cvt_pk_bf16_f32 v85, v58, v59
  v_exp_f32 v61, v61
  v_exp_f32 v62, v62
  v_cvt_pk_bf16_f32 v86, v60, v61
  v_exp_f32 v63, v63
  s_waitcnt lgkmcnt(0)
  ds_read_b128 v[108:111], v196 offset:9216
  v_cvt_pk_bf16_f32 v87, v62, v63
  v_mfma_f32_32x32x16_bf16 v[48:63], v[92:95], v[4:7], 0
  v_exp_f32 v64, v64
  v_exp_f32 v65, v65
  v_exp_f32 v66, v66
  v_cvt_pk_bf16_f32 v80, v64, v65
  v_exp_f32 v67, v67
  v_mfma_f32_32x32x16_bf16 v[16:31], v[104:107], v[84:87], v[16:31]
  ds_read_b128 v[112:115], v196 offset:9984
  v_exp_f32 v68, v68
  v_cvt_pk_bf16_f32 v81, v66, v67
  v_exp_f32 v69, v69
  v_exp_f32 v70, v70
  v_cvt_pk_bf16_f32 v82, v68, v69
  v_exp_f32 v71, v71
  v_mfma_f32_32x32x8bf16_1k v[48:63], v[98:99], v[12:13], v[48:63]
  v_exp_f32 v72, v72
  v_cvt_pk_bf16_f32 v83, v70, v71
  v_exp_f32 v73, v73
  v_exp_f32 v74, v74
  v_cvt_pk_bf16_f32 v84, v72, v73
  v_exp_f32 v75, v75
  v_mfma_f32_32x32x16_bf16 v[32:47], v[100:103], v[80:83], v[32:47]
  v_exp_f32 v76, v76
  v_cvt_pk_bf16_f32 v85, v74, v75
  v_exp_f32 v77, v77
  v_exp_f32 v78, v78
  v_cvt_pk_bf16_f32 v86, v76, v77
  v_exp_f32 v79, v79
  s_waitcnt lgkmcnt(0)
  s_barrier
  s_add_u32 m0, s18, 110592
  s_add_u32 s23, s11, 172032
  buffer_load_dwordx4 v201, s[4:7], s23 offen offset:0 lds
  buffer_load_dwordx4 v201, s[4:7], s23 offen offset:1024 lds
  buffer_load_dwordx4 v201, s[4:7], s23 offen offset:2048 lds
  s_waitcnt vmcnt(0)
  v_add_f32 v116, v116, v120
  v_add_f32 v116, v116, v124
  v_add_f32 v116, v116, v128
  v_add_f32 v116, v116, v132
  v_add_f32 v116, v116, v136
  v_add_f32 v116, v116, v140
  v_add_f32 v116, v116, v144
  v_add_f32 v117, v117, v121
  v_add_f32 v117, v117, v125
  v_add_f32 v117, v117, v129
  v_add_f32 v117, v117, v133
  v_add_f32 v117, v117, v137
  v_add_f32 v117, v117, v141
  v_add_f32 v117, v117, v145
  v_add_f32 v118, v118, v122
  v_add_f32 v118, v118, v126
  v_add_f32 v118, v118, v130
  v_add_f32 v118, v118, v134
  v_add_f32 v118, v118, v138
  v_add_f32 v118, v118, v142
  v_add_f32 v118, v118, v146
  v_add_f32 v119, v119, v123
  v_add_f32 v119, v119, v127
  v_add_f32 v119, v119, v131
  v_add_f32 v119, v119, v135
  v_add_f32 v119, v119, v139
  v_add_f32 v119, v119, v143
  v_add_f32 v119, v119, v147
  v_lshlrev_b32 v216, 4, v0
  v_add_u32 v216, 69632, v216
  ds_write_b128 v216, v[116:119]
  ds_read_b128 v[88:91], v188 offset:0
  ds_read_b64 v[96:97], v191 offset:0
  v_cvt_pk_bf16_f32 v87, v78, v79
  v_mfma_f32_32x32x16_bf16 v[64:79], v[92:95], v[8:11], 0
  v_exp_f32 v48, v48
  v_exp_f32 v49, v49
  v_exp_f32 v50, v50
  v_cvt_pk_bf16_f32 v80, v48, v49
  v_exp_f32 v51, v51
  v_mfma_f32_32x32x16_bf16 v[32:47], v[104:107], v[84:87], v[32:47]
  v_exp_f32 v52, v52
  v_cvt_pk_bf16_f32 v81, v50, v51
  v_exp_f32 v53, v53
  v_exp_f32 v54, v54
  v_cvt_pk_bf16_f32 v82, v52, v53
  v_exp_f32 v55, v55
  v_mfma_f32_32x32x8bf16_1k v[64:79], v[98:99], v[14:15], v[64:79]
  v_exp_f32 v56, v56
  v_cvt_pk_bf16_f32 v83, v54, v55
  v_exp_f32 v57, v57
  v_exp_f32 v58, v58
  v_cvt_pk_bf16_f32 v84, v56, v57
  v_exp_f32 v59, v59
  v_mfma_f32_32x32x16_bf16 v[16:31], v[108:111], v[80:83], v[16:31]
  v_exp_f32 v60, v60
  v_cvt_pk_bf16_f32 v85, v58, v59
  v_exp_f32 v61, v61
  v_exp_f32 v62, v62
  v_cvt_pk_bf16_f32 v86, v60, v61
  v_exp_f32 v63, v63
  s_waitcnt lgkmcnt(0)
  ds_read_b128 v[100:103], v194 offset:0
  v_cvt_pk_bf16_f32 v87, v62, v63
  v_mfma_f32_32x32x16_bf16 v[48:63], v[88:91], v[4:7], 0
  v_exp_f32 v64, v64
  v_exp_f32 v65, v65
  v_exp_f32 v66, v66
  v_cvt_pk_bf16_f32 v80, v64, v65
  v_exp_f32 v67, v67
  v_mfma_f32_32x32x16_bf16 v[16:31], v[112:115], v[84:87], v[16:31]
  ds_read_b128 v[104:107], v194 offset:768
  v_exp_f32 v68, v68
  v_cvt_pk_bf16_f32 v81, v66, v67
  v_exp_f32 v69, v69
  v_exp_f32 v70, v70
  v_cvt_pk_bf16_f32 v82, v68, v69
  v_exp_f32 v71, v71
  v_mfma_f32_32x32x8bf16_1k v[48:63], v[96:97], v[12:13], v[48:63]
  v_exp_f32 v72, v72
  v_cvt_pk_bf16_f32 v83, v70, v71
  v_exp_f32 v73, v73
  v_exp_f32 v74, v74
  v_cvt_pk_bf16_f32 v84, v72, v73
  v_exp_f32 v75, v75
  v_mfma_f32_32x32x16_bf16 v[32:47], v[108:111], v[80:83], v[32:47]
  v_exp_f32 v76, v76
  v_cvt_pk_bf16_f32 v85, v74, v75
  v_exp_f32 v77, v77
  v_exp_f32 v78, v78
  v_cvt_pk_bf16_f32 v86, v76, v77
  v_exp_f32 v79, v79
  s_waitcnt lgkmcnt(0)
  ds_read_b128 v[92:95], v188 offset:3072
  ds_read_b64 v[98:99], v191 offset:3072
  v_cvt_pk_bf16_f32 v87, v78, v79
  v_mfma_f32_32x32x16_bf16 v[64:79], v[88:91], v[8:11], 0
  v_exp_f32 v48, v48
  v_exp_f32 v49, v49
  v_exp_f32 v50, v50
  v_cvt_pk_bf16_f32 v80, v48, v49
  v_exp_f32 v51, v51
  v_mfma_f32_32x32x16_bf16 v[32:47], v[112:115], v[84:87], v[32:47]
  v_exp_f32 v52, v52
  v_cvt_pk_bf16_f32 v81, v50, v51
  v_exp_f32 v53, v53
  v_exp_f32 v54, v54
  v_cvt_pk_bf16_f32 v82, v52, v53
  v_exp_f32 v55, v55
  v_mfma_f32_32x32x8bf16_1k v[64:79], v[96:97], v[14:15], v[64:79]
  v_exp_f32 v56, v56
  v_cvt_pk_bf16_f32 v83, v54, v55
  v_exp_f32 v57, v57
  v_exp_f32 v58, v58
  v_cvt_pk_bf16_f32 v84, v56, v57
  v_exp_f32 v59, v59
  v_mfma_f32_32x32x16_bf16 v[16:31], v[100:103], v[80:83], v[16:31]
  v_exp_f32 v60, v60
  v_cvt_pk_bf16_f32 v85, v58, v59
  v_exp_f32 v61, v61
  v_exp_f32 v62, v62
  v_cvt_pk_bf16_f32 v86, v60, v61
  v_exp_f32 v63, v63
  s_waitcnt lgkmcnt(0)
  ds_read_b128 v[108:111], v194 offset:3072
  v_cvt_pk_bf16_f32 v87, v62, v63
  v_mfma_f32_32x32x16_bf16 v[48:63], v[92:95], v[4:7], 0
  v_exp_f32 v64, v64
  v_exp_f32 v65, v65
  v_exp_f32 v66, v66
  v_cvt_pk_bf16_f32 v80, v64, v65
  v_exp_f32 v67, v67
  v_mfma_f32_32x32x16_bf16 v[16:31], v[104:107], v[84:87], v[16:31]
  ds_read_b128 v[112:115], v194 offset:3840
  v_exp_f32 v68, v68
  v_cvt_pk_bf16_f32 v81, v66, v67
  v_exp_f32 v69, v69
  v_exp_f32 v70, v70
  v_cvt_pk_bf16_f32 v82, v68, v69
  v_exp_f32 v71, v71
  v_mfma_f32_32x32x8bf16_1k v[48:63], v[98:99], v[12:13], v[48:63]
  v_exp_f32 v72, v72
  v_cvt_pk_bf16_f32 v83, v70, v71
  v_exp_f32 v73, v73
  v_exp_f32 v74, v74
  v_cvt_pk_bf16_f32 v84, v72, v73
  v_exp_f32 v75, v75
  v_mfma_f32_32x32x16_bf16 v[32:47], v[100:103], v[80:83], v[32:47]
  v_exp_f32 v76, v76
  v_cvt_pk_bf16_f32 v85, v74, v75
  v_exp_f32 v77, v77
  v_exp_f32 v78, v78
  v_cvt_pk_bf16_f32 v86, v76, v77
  v_exp_f32 v79, v79
  s_waitcnt lgkmcnt(0)
  ds_read_b128 v[88:91], v188 offset:6144
  ds_read_b64 v[96:97], v191 offset:6144
  v_cvt_pk_bf16_f32 v87, v78, v79
  v_mfma_f32_32x32x16_bf16 v[64:79], v[92:95], v[8:11], 0
  v_exp_f32 v48, v48
  v_exp_f32 v49, v49
  v_exp_f32 v50, v50
  v_cvt_pk_bf16_f32 v80, v48, v49
  v_exp_f32 v51, v51
  v_mfma_f32_32x32x16_bf16 v[32:47], v[104:107], v[84:87], v[32:47]
  v_exp_f32 v52, v52
  v_cvt_pk_bf16_f32 v81, v50, v51
  v_exp_f32 v53, v53
  v_exp_f32 v54, v54
  v_cvt_pk_bf16_f32 v82, v52, v53
  v_exp_f32 v55, v55
  v_mfma_f32_32x32x8bf16_1k v[64:79], v[98:99], v[14:15], v[64:79]
  v_exp_f32 v56, v56
  v_cvt_pk_bf16_f32 v83, v54, v55
  v_exp_f32 v57, v57
  v_exp_f32 v58, v58
  v_cvt_pk_bf16_f32 v84, v56, v57
  v_exp_f32 v59, v59
  v_mfma_f32_32x32x16_bf16 v[16:31], v[108:111], v[80:83], v[16:31]
  v_exp_f32 v60, v60
  v_cvt_pk_bf16_f32 v85, v58, v59
  v_exp_f32 v61, v61
  v_exp_f32 v62, v62
  v_cvt_pk_bf16_f32 v86, v60, v61
  v_exp_f32 v63, v63
  s_waitcnt lgkmcnt(0)
  ds_read_b128 v[100:103], v194 offset:6144
  v_cvt_pk_bf16_f32 v87, v62, v63
  v_mfma_f32_32x32x16_bf16 v[48:63], v[88:91], v[4:7], 0
  v_exp_f32 v64, v64
  v_exp_f32 v65, v65
  v_exp_f32 v66, v66
  v_cvt_pk_bf16_f32 v80, v64, v65
  v_exp_f32 v67, v67
  v_mfma_f32_32x32x16_bf16 v[16:31], v[112:115], v[84:87], v[16:31]
  ds_read_b128 v[104:107], v194 offset:6912
  v_exp_f32 v68, v68
  v_cvt_pk_bf16_f32 v81, v66, v67
  v_exp_f32 v69, v69
  v_exp_f32 v70, v70
  v_cvt_pk_bf16_f32 v82, v68, v69
  v_exp_f32 v71, v71
  v_mfma_f32_32x32x8bf16_1k v[48:63], v[96:97], v[12:13], v[48:63]
  v_exp_f32 v72, v72
  v_cvt_pk_bf16_f32 v83, v70, v71
  v_exp_f32 v73, v73
  v_exp_f32 v74, v74
  v_cvt_pk_bf16_f32 v84, v72, v73
  v_exp_f32 v75, v75
  v_mfma_f32_32x32x16_bf16 v[32:47], v[108:111], v[80:83], v[32:47]
  v_exp_f32 v76, v76
  v_cvt_pk_bf16_f32 v85, v74, v75
  v_exp_f32 v77, v77
  v_exp_f32 v78, v78
  v_cvt_pk_bf16_f32 v86, v76, v77
  v_exp_f32 v79, v79
  s_waitcnt lgkmcnt(0)
  ds_read_b128 v[92:95], v188 offset:9216
  ds_read_b64 v[98:99], v191 offset:9216
  v_cvt_pk_bf16_f32 v87, v78, v79
  v_mfma_f32_32x32x16_bf16 v[64:79], v[88:91], v[8:11], 0
  v_exp_f32 v48, v48
  v_exp_f32 v49, v49
  v_exp_f32 v50, v50
  v_cvt_pk_bf16_f32 v80, v48, v49
  v_exp_f32 v51, v51
  v_mfma_f32_32x32x16_bf16 v[32:47], v[112:115], v[84:87], v[32:47]
  v_exp_f32 v52, v52
  v_cvt_pk_bf16_f32 v81, v50, v51
  v_exp_f32 v53, v53
  v_exp_f32 v54, v54
  v_cvt_pk_bf16_f32 v82, v52, v53
  v_exp_f32 v55, v55
  v_mfma_f32_32x32x8bf16_1k v[64:79], v[96:97], v[14:15], v[64:79]
  v_exp_f32 v56, v56
  v_cvt_pk_bf16_f32 v83, v54, v55
  v_exp_f32 v57, v57
  v_exp_f32 v58, v58
  v_cvt_pk_bf16_f32 v84, v56, v57
  v_exp_f32 v59, v59
  v_mfma_f32_32x32x16_bf16 v[16:31], v[100:103], v[80:83], v[16:31]
  v_exp_f32 v60, v60
  v_cvt_pk_bf16_f32 v85, v58, v59
  v_exp_f32 v61, v61
  v_exp_f32 v62, v62
  v_cvt_pk_bf16_f32 v86, v60, v61
  v_exp_f32 v63, v63
  s_waitcnt lgkmcnt(0)
  ds_read_b128 v[108:111], v194 offset:9216
  v_cvt_pk_bf16_f32 v87, v62, v63
  v_mfma_f32_32x32x16_bf16 v[48:63], v[92:95], v[4:7], 0
  v_exp_f32 v64, v64
  v_exp_f32 v65, v65
  v_exp_f32 v66, v66
  v_cvt_pk_bf16_f32 v80, v64, v65
  v_exp_f32 v67, v67
  v_mfma_f32_32x32x16_bf16 v[16:31], v[104:107], v[84:87], v[16:31]
  ds_read_b128 v[112:115], v194 offset:9984
  v_exp_f32 v68, v68
  v_cvt_pk_bf16_f32 v81, v66, v67
  v_exp_f32 v69, v69
  v_exp_f32 v70, v70
  v_cvt_pk_bf16_f32 v82, v68, v69
  v_exp_f32 v71, v71
  v_mfma_f32_32x32x8bf16_1k v[48:63], v[98:99], v[12:13], v[48:63]
  v_exp_f32 v72, v72
  v_cvt_pk_bf16_f32 v83, v70, v71
  v_exp_f32 v73, v73
  v_exp_f32 v74, v74
  v_cvt_pk_bf16_f32 v84, v72, v73
  v_exp_f32 v75, v75
  v_mfma_f32_32x32x16_bf16 v[32:47], v[100:103], v[80:83], v[32:47]
  v_exp_f32 v76, v76
  v_cvt_pk_bf16_f32 v85, v74, v75
  v_exp_f32 v77, v77
  v_exp_f32 v78, v78
  v_cvt_pk_bf16_f32 v86, v76, v77
  v_exp_f32 v79, v79
  s_waitcnt lgkmcnt(0)
  s_barrier
  s_nop 4
  s_mul_i32 s59, s8, 2560
  s_add_u32 s59, s59, 0
  v_lshlrev_b32 v214, 2, v1
  v_add_u32 v214, s59, v214
  ds_read_b32 v148, v214 offset:0
  ds_read_b32 v149, v214 offset:256
  ds_read_b32 v150, v214 offset:512
  ds_read_b32 v151, v214 offset:768
  ds_read_b32 v152, v214 offset:1024
  v_mov_b32 v153, 0
  ds_read_b32 v154, v214 offset:1280
  ds_read_b32 v155, v214 offset:1536
  ds_read_b32 v156, v214 offset:1792
  ds_read_b32 v157, v214 offset:2048
  ds_read_b32 v158, v214 offset:2304
  v_mov_b32 v159, 0
  v_lshrrev_b32 v215, 3, v2
  v_and_b32 v216, 3, v2
  v_lshl_add_u32 v215, v215, 2, v216
  v_lshlrev_b32 v215, 8, v215
  v_bfe_u32 v216, v2, 2, 1
  v_lshl_add_u32 v215, v216, 7, v215
  v_lshl_add_u32 v215, v3, 4, v215
  v_add_u32 v215, 69632, v215
  ds_read_b128 v[224:227], v215 offset:0
  ds_read_b128 v[228:231], v215 offset:32
  ds_read_b128 v[232:235], v215 offset:64
  ds_read_b128 v[236:239], v215 offset:4096
  ds_read_b128 v[240:243], v215 offset:4128
  ds_read_b128 v[244:247], v215 offset:4160
  v_cmp_eq_u32 vcc, 21, v2
  s_waitcnt lgkmcnt(0)
  s_nop 0
  v_cndmask_b32 v224, v224, 1.0, vcc
  v_cndmask_b32 v225, v225, 1.0, vcc
  v_cndmask_b32 v226, v226, 1.0, vcc
  v_cndmask_b32 v227, v227, 1.0, vcc
  v_cndmask_b32 v228, v228, 1.0, vcc
  v_cndmask_b32 v229, v229, 1.0, vcc
  v_cndmask_b32 v230, v230, 1.0, vcc
  v_cndmask_b32 v231, v231, 1.0, vcc
  v_cndmask_b32 v232, v232, 1.0, vcc
  v_cndmask_b32 v233, v233, 1.0, vcc
  v_cndmask_b32 v234, v234, 1.0, vcc
  v_cndmask_b32 v235, v235, 1.0, vcc
  v_cndmask_b32 v236, v236, 1.0, vcc
  v_cndmask_b32 v237, v237, 1.0, vcc
  v_cndmask_b32 v238, v238, 1.0, vcc
  v_cndmask_b32 v239, v239, 1.0, vcc
  v_cndmask_b32 v240, v240, 1.0, vcc
  v_cndmask_b32 v241, v241, 1.0, vcc
  v_cndmask_b32 v242, v242, 1.0, vcc
  v_cndmask_b32 v243, v243, 1.0, vcc
  v_cndmask_b32 v244, v244, 1.0, vcc
  v_cndmask_b32 v245, v245, 1.0, vcc
  v_cndmask_b32 v246, v246, 1.0, vcc
  v_cndmask_b32 v247, v247, 1.0, vcc
  v_cvt_pk_bf16_f32 v160, v224, v225
  v_cvt_pk_bf16_f32 v161, v226, v227
  v_cvt_pk_bf16_f32 v162, v228, v229
  v_cvt_pk_bf16_f32 v163, v230, v231
  v_cvt_pk_bf16_f32 v164, v232, v233
  v_cvt_pk_bf16_f32 v165, v234, v235
  v_cvt_pk_bf16_f32 v166, v236, v237
  v_cvt_pk_bf16_f32 v167, v238, v239
  v_cvt_pk_bf16_f32 v168, v240, v241
  v_cvt_pk_bf16_f32 v169, v242, v243
  v_cvt_pk_bf16_f32 v170, v244, v245
  v_cvt_pk_bf16_f32 v171, v246, v247
  v_mfma_f32_32x32x8bf16_1k v[116:131], v[160:161], v[148:149], 0
  v_mfma_f32_32x32x8bf16_1k v[116:131], v[162:163], v[150:151], v[116:131]
  v_mfma_f32_32x32x8bf16_1k v[116:131], v[164:165], v[152:153], v[116:131]
  v_mfma_f32_32x32x8bf16_1k v[132:147], v[166:167], v[154:155], 0
  v_mfma_f32_32x32x8bf16_1k v[132:147], v[168:169], v[156:157], v[132:147]
  v_mfma_f32_32x32x8bf16_1k v[132:147], v[170:171], v[158:159], v[132:147]
  s_nop 8
  v_mov_b32 v212, v124
  v_mov_b32 v213, v124
  s_nop 1
  v_permlane32_swap_b32 v212, v213
  v_mov_b32 v214, v125
  v_mov_b32 v215, v125
  s_nop 1
  v_permlane32_swap_b32 v214, v215
  v_mov_b32 v216, v140
  v_mov_b32 v217, v140
  s_nop 1
  v_permlane32_swap_b32 v216, v217
  v_mov_b32 v218, v141
  v_mov_b32 v219, v141
  s_nop 1
  v_permlane32_swap_b32 v218, v219
  v_rcp_f32 v215, v215
  v_rcp_f32 v219, v219
  v_mul_f32 v213, v213, v215
  v_fma_f32 v213, v217, v219, v213
  v_add_f32 v213, 0x358637bd, v213
  v_rcp_f32 v213, v213
  v_sub_f32 v217, 1.0, v207
  v_mul_f32 v213, v213, v217
  v_mul_f32 v215, v215, v213
  v_mul_f32 v219, v219, v213
  v_mul_f32 v116, v116, v215
  v_fma_f32 v116, v132, v219, v116
  v_mul_f32 v117, v117, v215
  v_fma_f32 v117, v133, v219, v117
  v_mul_f32 v118, v118, v215
  v_fma_f32 v118, v134, v219, v118
  v_mul_f32 v119, v119, v215
  v_fma_f32 v119, v135, v219, v119
  v_mul_f32 v120, v120, v215
  v_fma_f32 v120, v136, v219, v120
  v_mul_f32 v121, v121, v215
  v_fma_f32 v121, v137, v219, v121
  v_mul_f32 v122, v122, v215
  v_fma_f32 v122, v138, v219, v122
  v_mul_f32 v123, v123, v215
  v_fma_f32 v123, v139, v219, v123
  v_mul_f32 v124, v124, v215
  v_fma_f32 v124, v140, v219, v124
  v_mul_f32 v125, v125, v215
  v_fma_f32 v125, v141, v219, v125
  v_mul_f32 v126, v126, v215
  v_fma_f32 v126, v142, v219, v126
  v_mul_f32 v127, v127, v215
  v_fma_f32 v127, v143, v219, v127
  v_cvt_pk_bf16_f32 v172, v116, v117
  v_cvt_pk_bf16_f32 v173, v118, v119
  v_cvt_pk_bf16_f32 v174, v120, v121
  v_cvt_pk_bf16_f32 v175, v122, v123
  v_cvt_pk_bf16_f32 v176, v124, v125
  v_cvt_pk_bf16_f32 v177, v126, v127
  v_lshrrev_b32 v216, 4, v208
  s_mov_b32 s27, 40960
  v_mul_lo_u32 v216, v216, s27
  v_and_b32 v217, 15, v208
  v_lshlrev_b32 v217, 4, v217
  v_add_u32 v216, v216, v217
  s_mul_i32 s28, s9, 5
  s_add_u32 s28, s28, 160
  s_mov_b32 s34, 10485760
  s_add_u32 s29, s28, 0
  s_lshr_b32 s30, s29, 3
  s_lshl_b32 s30, s30, 10
  s_and_b32 s33, s29, 7
  s_lshr_b32 s33, s33, 1
  s_lshl_b32 s33, s33, 8
  s_add_u32 s30, s30, s33
  s_and_b32 s33, s29, 1
  s_lshl_b32 s33, s33, 3
  s_add_u32 s30, s30, s33
  s_add_u32 s29, s29, 1
  s_lshr_b32 s31, s29, 3
  s_lshl_b32 s31, s31, 10
  s_and_b32 s33, s29, 7
  s_lshr_b32 s33, s33, 1
  s_lshl_b32 s33, s33, 8
  s_add_u32 s31, s31, s33
  s_and_b32 s33, s29, 1
  s_lshl_b32 s33, s33, 3
  s_add_u32 s31, s31, s33
  v_mov_b32 v217, s30
  v_mov_b32 v218, s31
  v_cndmask_b32 v217, v217, v218, s[16:17]
  v_add_u32 v217, v217, v216
  buffer_store_dwordx2 v[172:173], v217, s[4:7], s34 offen
  s_add_u32 s29, s28, 2
  s_lshr_b32 s30, s29, 3
  s_lshl_b32 s30, s30, 10
  s_and_b32 s33, s29, 7
  s_lshr_b32 s33, s33, 1
  s_lshl_b32 s33, s33, 8
  s_add_u32 s30, s30, s33
  s_and_b32 s33, s29, 1
  s_lshl_b32 s33, s33, 3
  s_add_u32 s30, s30, s33
  s_add_u32 s29, s29, 1
  s_lshr_b32 s31, s29, 3
  s_lshl_b32 s31, s31, 10
  s_and_b32 s33, s29, 7
  s_lshr_b32 s33, s33, 1
  s_lshl_b32 s33, s33, 8
  s_add_u32 s31, s31, s33
  s_and_b32 s33, s29, 1
  s_lshl_b32 s33, s33, 3
  s_add_u32 s31, s31, s33
  v_mov_b32 v217, s30
  v_mov_b32 v218, s31
  v_cndmask_b32 v217, v217, v218, s[16:17]
  v_add_u32 v217, v217, v216
  buffer_store_dwordx2 v[174:175], v217, s[4:7], s34 offen
  s_add_u32 s29, s28, 4
  s_lshr_b32 s30, s29, 3
  s_lshl_b32 s30, s30, 10
  s_and_b32 s33, s29, 7
  s_lshr_b32 s33, s33, 1
  s_lshl_b32 s33, s33, 8
  s_add_u32 s30, s30, s33
  s_and_b32 s33, s29, 1
  s_lshl_b32 s33, s33, 3
  s_add_u32 s30, s30, s33
  s_add_u32 s29, s29, 1
  s_lshr_b32 s31, s29, 3
  s_lshl_b32 s31, s31, 10
  s_and_b32 s33, s29, 7
  s_lshr_b32 s33, s33, 1
  s_lshl_b32 s33, s33, 8
  s_add_u32 s31, s31, s33
  s_and_b32 s33, s29, 1
  s_lshl_b32 s33, s33, 3
  s_add_u32 s31, s31, s33
  v_mov_b32 v217, s30
  v_mov_b32 v218, s31
  v_cndmask_b32 v217, v217, v218, s[16:17]
  v_add_u32 v217, v217, v216
  s_mov_b32 exec_hi, 0
  buffer_store_dwordx2 v[176:177], v217, s[4:7], s34 offen
  s_mov_b32 exec_hi, -1
  s_nop 4
  ds_read_b128 v[88:91], v189 offset:0
  ds_read_b64 v[96:97], v192 offset:0
  v_cvt_pk_bf16_f32 v87, v78, v79
  v_mfma_f32_32x32x16_bf16 v[64:79], v[92:95], v[8:11], 0
  v_exp_f32 v48, v48
  v_exp_f32 v49, v49
  v_exp_f32 v50, v50
  v_cvt_pk_bf16_f32 v80, v48, v49
  v_exp_f32 v51, v51
  v_mfma_f32_32x32x16_bf16 v[32:47], v[104:107], v[84:87], v[32:47]
  v_exp_f32 v52, v52
  v_cvt_pk_bf16_f32 v81, v50, v51
  v_exp_f32 v53, v53
  v_exp_f32 v54, v54
  v_cvt_pk_bf16_f32 v82, v52, v53
  v_exp_f32 v55, v55
  v_mfma_f32_32x32x8bf16_1k v[64:79], v[98:99], v[14:15], v[64:79]
  v_exp_f32 v56, v56
  v_cvt_pk_bf16_f32 v83, v54, v55
  v_exp_f32 v57, v57
  v_exp_f32 v58, v58
  v_cvt_pk_bf16_f32 v84, v56, v57
  v_exp_f32 v59, v59
  v_mfma_f32_32x32x16_bf16 v[16:31], v[108:111], v[80:83], v[16:31]
  v_exp_f32 v60, v60
  v_cvt_pk_bf16_f32 v85, v58, v59
  v_exp_f32 v61, v61
  v_exp_f32 v62, v62
  v_cvt_pk_bf16_f32 v86, v60, v61
  v_exp_f32 v63, v63
  s_waitcnt lgkmcnt(0)
  ds_read_b128 v[100:103], v195 offset:0
  v_cvt_pk_bf16_f32 v87, v62, v63
  v_mfma_f32_32x32x16_bf16 v[48:63], v[88:91], v[4:7], 0
  v_exp_f32 v64, v64
  v_exp_f32 v65, v65
  v_exp_f32 v66, v66
  v_cvt_pk_bf16_f32 v80, v64, v65
  v_exp_f32 v67, v67
  v_mfma_f32_32x32x16_bf16 v[16:31], v[112:115], v[84:87], v[16:31]
  ds_read_b128 v[104:107], v195 offset:768
  v_exp_f32 v68, v68
  v_cvt_pk_bf16_f32 v81, v66, v67
  v_exp_f32 v69, v69
  v_exp_f32 v70, v70
  v_cvt_pk_bf16_f32 v82, v68, v69
  v_exp_f32 v71, v71
  v_mfma_f32_32x32x8bf16_1k v[48:63], v[96:97], v[12:13], v[48:63]
  v_exp_f32 v72, v72
  v_cvt_pk_bf16_f32 v83, v70, v71
  v_exp_f32 v73, v73
  v_exp_f32 v74, v74
  v_cvt_pk_bf16_f32 v84, v72, v73
  v_exp_f32 v75, v75
  v_mfma_f32_32x32x16_bf16 v[32:47], v[108:111], v[80:83], v[32:47]
  v_exp_f32 v76, v76
  v_cvt_pk_bf16_f32 v85, v74, v75
  v_exp_f32 v77, v77
  v_exp_f32 v78, v78
  v_cvt_pk_bf16_f32 v86, v76, v77
  v_exp_f32 v79, v79
  s_waitcnt lgkmcnt(0)
  ds_read_b128 v[92:95], v189 offset:3072
  ds_read_b64 v[98:99], v192 offset:3072
  v_cvt_pk_bf16_f32 v87, v78, v79
  v_mfma_f32_32x32x16_bf16 v[64:79], v[88:91], v[8:11], 0
  v_exp_f32 v48, v48
  v_exp_f32 v49, v49
  v_exp_f32 v50, v50
  v_cvt_pk_bf16_f32 v80, v48, v49
  v_exp_f32 v51, v51
  v_mfma_f32_32x32x16_bf16 v[32:47], v[112:115], v[84:87], v[32:47]
  v_exp_f32 v52, v52
  v_cvt_pk_bf16_f32 v81, v50, v51
  v_exp_f32 v53, v53
  v_exp_f32 v54, v54
  v_cvt_pk_bf16_f32 v82, v52, v53
  v_exp_f32 v55, v55
  v_mfma_f32_32x32x8bf16_1k v[64:79], v[96:97], v[14:15], v[64:79]
  v_exp_f32 v56, v56
  v_cvt_pk_bf16_f32 v83, v54, v55
  v_exp_f32 v57, v57
  v_exp_f32 v58, v58
  v_cvt_pk_bf16_f32 v84, v56, v57
  v_exp_f32 v59, v59
  v_mfma_f32_32x32x16_bf16 v[16:31], v[100:103], v[80:83], v[16:31]
  v_exp_f32 v60, v60
  v_cvt_pk_bf16_f32 v85, v58, v59
  v_exp_f32 v61, v61
  v_exp_f32 v62, v62
  v_cvt_pk_bf16_f32 v86, v60, v61
  v_exp_f32 v63, v63
  s_waitcnt lgkmcnt(0)
  ds_read_b128 v[108:111], v195 offset:3072
  v_cvt_pk_bf16_f32 v87, v62, v63
  v_mfma_f32_32x32x16_bf16 v[48:63], v[92:95], v[4:7], 0
  v_exp_f32 v64, v64
  v_exp_f32 v65, v65
  v_exp_f32 v66, v66
  v_cvt_pk_bf16_f32 v80, v64, v65
  v_exp_f32 v67, v67
  v_mfma_f32_32x32x16_bf16 v[16:31], v[104:107], v[84:87], v[16:31]
  ds_read_b128 v[112:115], v195 offset:3840
  v_exp_f32 v68, v68
  v_cvt_pk_bf16_f32 v81, v66, v67
  v_exp_f32 v69, v69
  v_exp_f32 v70, v70
  v_cvt_pk_bf16_f32 v82, v68, v69
  v_exp_f32 v71, v71
  v_mfma_f32_32x32x8bf16_1k v[48:63], v[98:99], v[12:13], v[48:63]
  v_exp_f32 v72, v72
  v_cvt_pk_bf16_f32 v83, v70, v71
  v_exp_f32 v73, v73
  v_exp_f32 v74, v74
  v_cvt_pk_bf16_f32 v84, v72, v73
  v_exp_f32 v75, v75
  v_mfma_f32_32x32x16_bf16 v[32:47], v[100:103], v[80:83], v[32:47]
  v_exp_f32 v76, v76
  v_cvt_pk_bf16_f32 v85, v74, v75
  v_exp_f32 v77, v77
  v_exp_f32 v78, v78
  v_cvt_pk_bf16_f32 v86, v76, v77
  v_exp_f32 v79, v79
  s_waitcnt lgkmcnt(0)
  ds_read_b128 v[88:91], v189 offset:6144
  ds_read_b64 v[96:97], v192 offset:6144
  v_cvt_pk_bf16_f32 v87, v78, v79
  v_mfma_f32_32x32x16_bf16 v[64:79], v[92:95], v[8:11], 0
  v_exp_f32 v48, v48
  v_exp_f32 v49, v49
  v_exp_f32 v50, v50
  v_cvt_pk_bf16_f32 v80, v48, v49
  v_exp_f32 v51, v51
  v_mfma_f32_32x32x16_bf16 v[32:47], v[104:107], v[84:87], v[32:47]
  v_exp_f32 v52, v52
  v_cvt_pk_bf16_f32 v81, v50, v51
  v_exp_f32 v53, v53
  v_exp_f32 v54, v54
  v_cvt_pk_bf16_f32 v82, v52, v53
  v_exp_f32 v55, v55
  v_mfma_f32_32x32x8bf16_1k v[64:79], v[98:99], v[14:15], v[64:79]
  v_exp_f32 v56, v56
  v_cvt_pk_bf16_f32 v83, v54, v55
  v_exp_f32 v57, v57
  v_exp_f32 v58, v58
  v_cvt_pk_bf16_f32 v84, v56, v57
  v_exp_f32 v59, v59
  v_mfma_f32_32x32x16_bf16 v[16:31], v[108:111], v[80:83], v[16:31]
  v_exp_f32 v60, v60
  v_cvt_pk_bf16_f32 v85, v58, v59
  v_exp_f32 v61, v61
  v_exp_f32 v62, v62
  v_cvt_pk_bf16_f32 v86, v60, v61
  v_exp_f32 v63, v63
  s_waitcnt lgkmcnt(0)
  ds_read_b128 v[100:103], v195 offset:6144
  v_cvt_pk_bf16_f32 v87, v62, v63
  v_mfma_f32_32x32x16_bf16 v[48:63], v[88:91], v[4:7], 0
  v_exp_f32 v64, v64
  v_exp_f32 v65, v65
  v_exp_f32 v66, v66
  v_cvt_pk_bf16_f32 v80, v64, v65
  v_exp_f32 v67, v67
  v_mfma_f32_32x32x16_bf16 v[16:31], v[112:115], v[84:87], v[16:31]
  ds_read_b128 v[104:107], v195 offset:6912
  v_exp_f32 v68, v68
  v_cvt_pk_bf16_f32 v81, v66, v67
  v_exp_f32 v69, v69
  v_exp_f32 v70, v70
  v_cvt_pk_bf16_f32 v82, v68, v69
  v_exp_f32 v71, v71
  v_mfma_f32_32x32x8bf16_1k v[48:63], v[96:97], v[12:13], v[48:63]
  v_exp_f32 v72, v72
  v_cvt_pk_bf16_f32 v83, v70, v71
  v_exp_f32 v73, v73
  v_exp_f32 v74, v74
  v_cvt_pk_bf16_f32 v84, v72, v73
  v_exp_f32 v75, v75
  v_mfma_f32_32x32x16_bf16 v[32:47], v[108:111], v[80:83], v[32:47]
  v_exp_f32 v76, v76
  v_cvt_pk_bf16_f32 v85, v74, v75
  v_exp_f32 v77, v77
  v_exp_f32 v78, v78
  v_cvt_pk_bf16_f32 v86, v76, v77
  v_exp_f32 v79, v79
  s_waitcnt lgkmcnt(0)
  ds_read_b128 v[92:95], v189 offset:9216
  ds_read_b64 v[98:99], v192 offset:9216
  v_cvt_pk_bf16_f32 v87, v78, v79
  v_mfma_f32_32x32x16_bf16 v[64:79], v[88:91], v[8:11], 0
  v_exp_f32 v48, v48
  v_exp_f32 v49, v49
  v_exp_f32 v50, v50
  v_cvt_pk_bf16_f32 v80, v48, v49
  v_exp_f32 v51, v51
  v_mfma_f32_32x32x16_bf16 v[32:47], v[112:115], v[84:87], v[32:47]
  v_exp_f32 v52, v52
  v_cvt_pk_bf16_f32 v81, v50, v51
  v_exp_f32 v53, v53
  v_exp_f32 v54, v54
  v_cvt_pk_bf16_f32 v82, v52, v53
  v_exp_f32 v55, v55
  v_mfma_f32_32x32x8bf16_1k v[64:79], v[96:97], v[14:15], v[64:79]
  v_exp_f32 v56, v56
  v_cvt_pk_bf16_f32 v83, v54, v55
  v_exp_f32 v57, v57
  v_exp_f32 v58, v58
  v_cvt_pk_bf16_f32 v84, v56, v57
  v_exp_f32 v59, v59
  v_mfma_f32_32x32x16_bf16 v[16:31], v[100:103], v[80:83], v[16:31]
  v_exp_f32 v60, v60
  v_cvt_pk_bf16_f32 v85, v58, v59
  v_exp_f32 v61, v61
  v_exp_f32 v62, v62
  v_cvt_pk_bf16_f32 v86, v60, v61
  v_exp_f32 v63, v63
  s_waitcnt lgkmcnt(0)
  ds_read_b128 v[108:111], v195 offset:9216
  v_cvt_pk_bf16_f32 v87, v62, v63
  v_mfma_f32_32x32x16_bf16 v[48:63], v[92:95], v[4:7], 0
  v_exp_f32 v64, v64
  v_exp_f32 v65, v65
  v_exp_f32 v66, v66
  v_cvt_pk_bf16_f32 v80, v64, v65
  v_exp_f32 v67, v67
  v_mfma_f32_32x32x16_bf16 v[16:31], v[104:107], v[84:87], v[16:31]
  ds_read_b128 v[112:115], v195 offset:9984
  v_exp_f32 v68, v68
  v_cvt_pk_bf16_f32 v81, v66, v67
  v_exp_f32 v69, v69
  v_exp_f32 v70, v70
  v_cvt_pk_bf16_f32 v82, v68, v69
  v_exp_f32 v71, v71
  v_mfma_f32_32x32x8bf16_1k v[48:63], v[98:99], v[12:13], v[48:63]
  v_exp_f32 v72, v72
  v_cvt_pk_bf16_f32 v83, v70, v71
  v_exp_f32 v73, v73
  v_exp_f32 v74, v74
  v_cvt_pk_bf16_f32 v84, v72, v73
  v_exp_f32 v75, v75
  v_mfma_f32_32x32x16_bf16 v[32:47], v[100:103], v[80:83], v[32:47]
  v_exp_f32 v76, v76
  v_cvt_pk_bf16_f32 v85, v74, v75
  v_exp_f32 v77, v77
  v_exp_f32 v78, v78
  v_cvt_pk_bf16_f32 v86, v76, v77
  v_exp_f32 v79, v79
  s_waitcnt lgkmcnt(0)
  v_cvt_pk_bf16_f32 v87, v78, v79
  v_mfma_f32_32x32x16_bf16 v[64:79], v[92:95], v[8:11], 0
  v_exp_f32 v48, v48
  v_exp_f32 v49, v49
  v_exp_f32 v50, v50
  v_cvt_pk_bf16_f32 v80, v48, v49
  v_exp_f32 v51, v51
  v_mfma_f32_32x32x16_bf16 v[32:47], v[104:107], v[84:87], v[32:47]
  v_exp_f32 v52, v52
  v_cvt_pk_bf16_f32 v81, v50, v51
  v_exp_f32 v53, v53
  v_exp_f32 v54, v54
  v_cvt_pk_bf16_f32 v82, v52, v53
  v_exp_f32 v55, v55
  v_mfma_f32_32x32x8bf16_1k v[64:79], v[98:99], v[14:15], v[64:79]
  v_exp_f32 v56, v56
  v_cvt_pk_bf16_f32 v83, v54, v55
  v_exp_f32 v57, v57
  v_exp_f32 v58, v58
  v_cvt_pk_bf16_f32 v84, v56, v57
  v_exp_f32 v59, v59
  v_mfma_f32_32x32x16_bf16 v[16:31], v[108:111], v[80:83], v[16:31]
  v_exp_f32 v60, v60
  v_cvt_pk_bf16_f32 v85, v58, v59
  v_exp_f32 v61, v61
  v_exp_f32 v62, v62
  v_cvt_pk_bf16_f32 v86, v60, v61
  v_exp_f32 v63, v63
  s_waitcnt lgkmcnt(0)
  v_cvt_pk_bf16_f32 v87, v62, v63
  v_exp_f32 v64, v64
  v_exp_f32 v65, v65
  v_exp_f32 v66, v66
  v_cvt_pk_bf16_f32 v80, v64, v65
  v_exp_f32 v67, v67
  v_mfma_f32_32x32x16_bf16 v[16:31], v[112:115], v[84:87], v[16:31]
  v_exp_f32 v68, v68
  v_cvt_pk_bf16_f32 v81, v66, v67
  v_exp_f32 v69, v69
  v_exp_f32 v70, v70
  v_cvt_pk_bf16_f32 v82, v68, v69
  v_exp_f32 v71, v71
  v_exp_f32 v72, v72
  v_cvt_pk_bf16_f32 v83, v70, v71
  v_exp_f32 v73, v73
  v_exp_f32 v74, v74
  v_cvt_pk_bf16_f32 v84, v72, v73
  v_exp_f32 v75, v75
  v_mfma_f32_32x32x16_bf16 v[32:47], v[108:111], v[80:83], v[32:47]
  v_exp_f32 v76, v76
  v_cvt_pk_bf16_f32 v85, v74, v75
  v_exp_f32 v77, v77
  v_exp_f32 v78, v78
  v_cvt_pk_bf16_f32 v86, v76, v77
  v_exp_f32 v79, v79
  s_nop 0
  v_cvt_pk_bf16_f32 v87, v78, v79
  s_nop 1
  v_mfma_f32_32x32x16_bf16 v[32:47], v[112:115], v[84:87], v[32:47]
  s_nop 11
  v_lshlrev_b32 v212, 2, v1
  s_mul_i32 s27, s37, 6144
  s_mul_i32 s29, s38, 3072
  s_add_u32 s27, s27, s29
  s_add_u32 s27, s27, 20480
  v_add_u32 v213, s27, v212
  s_xor_b32 s29, s27, 0
  s_mul_i32 s29, s37, 6144
  s_xor_b32 s30, s38, 1
  s_mul_i32 s30, s30, 3072
  s_add_u32 s29, s29, s30
  s_add_u32 s29, s29, 20480
  v_add_u32 v214, s29, v212
  s_cmp_eq_u32 s38, 0
  s_cbranch_scc1 L_att_kernel_c0
  ds_write_b32 v213, v16 offset:0
  ds_write_b32 v213, v17 offset:256
  ds_write_b32 v213, v18 offset:512
  ds_write_b32 v213, v19 offset:768
  ds_write_b32 v213, v20 offset:1024
  ds_write_b32 v213, v21 offset:1280
  ds_write_b32 v213, v22 offset:1536
  ds_write_b32 v213, v23 offset:1792
  ds_write_b32 v213, v24 offset:2048
  ds_write_b32 v213, v25 offset:2304
  ds_write_b32 v213, v26 offset:2560
  ds_write_b32 v213, v27 offset:2816
  v_mov_b32 v16, v32
  v_mov_b32 v17, v33
  v_mov_b32 v18, v34
  v_mov_b32 v19, v35
  v_mov_b32 v20, v36
  v_mov_b32 v21, v37
  v_mov_b32 v22, v38
  v_mov_b32 v23, v39
  v_mov_b32 v24, v40
  v_mov_b32 v25, v41
  v_mov_b32 v26, v42
  v_mov_b32 v27, v43
  v_mov_b32 v28, v44
  v_mov_b32 v29, v45
  v_mov_b32 v30, v46
  v_mov_b32 v31, v47
  v_mov_b32 v4, v8
  v_mov_b32 v5, v9
  v_mov_b32 v6, v10
  v_mov_b32 v7, v11
  v_mov_b32 v12, v14
  v_mov_b32 v13, v15
  s_branch L_att_kernel_c1
L_att_kernel_c0:
  ds_write_b32 v213, v32 offset:0
  ds_write_b32 v213, v33 offset:256
  ds_write_b32 v213, v34 offset:512
  ds_write_b32 v213, v35 offset:768
  ds_write_b32 v213, v36 offset:1024
  ds_write_b32 v213, v37 offset:1280
  ds_write_b32 v213, v38 offset:1536
  ds_write_b32 v213, v39 offset:1792
  ds_write_b32 v213, v40 offset:2048
  ds_write_b32 v213, v41 offset:2304
  ds_write_b32 v213, v42 offset:2560
  ds_write_b32 v213, v43 offset:2816
L_att_kernel_c1:
  s_waitcnt lgkmcnt(0)
  s_barrier
  ds_read_b32 v48, v214 offset:0
  ds_read_b32 v49, v214 offset:256
  ds_read_b32 v50, v214 offset:512
  ds_read_b32 v51, v214 offset:768
  ds_read_b32 v52, v214 offset:1024
  ds_read_b32 v53, v214 offset:1280
  ds_read_b32 v54, v214 offset:1536
  ds_read_b32 v55, v214 offset:1792
  ds_read_b32 v56, v214 offset:2048
  ds_read_b32 v57, v214 offset:2304
  ds_read_b32 v58, v214 offset:2560
  ds_read_b32 v59, v214 offset:2816
  s_waitcnt lgkmcnt(0)
  v_add_f32 v16, v16, v48
  v_add_f32 v17, v17, v49
  v_add_f32 v18, v18, v50
  v_add_f32 v19, v19, v51
  v_add_f32 v20, v20, v52
  v_add_f32 v21, v21, v53
  v_add_f32 v22, v22, v54
  v_add_f32 v23, v23, v55
  v_add_f32 v24, v24, v56
  v_add_f32 v25, v25, v57
  v_add_f32 v26, v26, v58
  v_add_f32 v27, v27, v59
  s_mov_b32 s25, 0
L_att_kernel_epi:
  s_nop 4
  v_add_f32 v212, |v16|, |v17|
  v_add_f32 v212, v212, |v18|
  v_add_f32 v212, v212, |v19|
  v_add_f32 v212, v212, |v20|
  v_add_f32 v212, v212, |v21|
  v_add_f32 v212, v212, |v22|
  v_add_f32 v212, v212, |v23|
  v_add_f32 v212, v212, |v24|
  v_add_f32 v213, |v25|, |v26|
  v_add_f32 v213, v213, |v27|
  v_cndmask_b32 v213, v213, 0, s[16:17]
  v_add_f32 v212, v212, v213
  s_mov_b32 s26, 0x7f000000
  v_cmp_nle_f32 vcc, v212, s26
  s_cmp_lg_u32 s25, 0
  s_cbranch_scc1 L_att_kernel_store
  s_cbranch_vccnz L_att_kernel_fallback
L_att_kernel_store:
  s_nop 4
  v_mov_b32 v212, v24
  v_mov_b32 v213, v24
  s_nop 1
  v_permlane32_swap_b32 v212, v213
  v_rcp_f32 v213, v213
  s_nop 0
  v_mul_f32 v213, v213, v207
  v_mul_f32 v16, v16, v213
  v_mul_f32 v17, v17, v213
  v_mul_f32 v18, v18, v213
  v_mul_f32 v19, v19, v213
  v_mul_f32 v20, v20, v213
  v_mul_f32 v21, v21, v213
  v_mul_f32 v22, v22, v213
  v_mul_f32 v23, v23, v213
  v_mul_f32 v24, v24, v213
  v_mul_f32 v25, v25, v213
  v_mul_f32 v26, v26, v213
  v_mul_f32 v27, v27, v213
  v_cvt_pk_bf16_f32 v48, v16, v17
  v_cvt_pk_bf16_f32 v49, v18, v19
  v_cvt_pk_bf16_f32 v50, v20, v21
  v_cvt_pk_bf16_f32 v51, v22, v23
  v_cvt_pk_bf16_f32 v52, v24, v25
  v_cvt_pk_bf16_f32 v53, v26, v27
  v_lshrrev_b32 v216, 4, v208
  s_mov_b32 s27, 40960
  v_mul_lo_u32 v216, v216, s27
  v_and_b32 v217, 15, v208
  v_lshlrev_b32 v217, 4, v217
  v_add_u32 v216, v216, v217
  s_mul_i32 s28, s9, 5
  s_mov_b32 s34, 10485760
  s_add_u32 s29, s28, 0
  s_lshr_b32 s30, s29, 3
  s_lshl_b32 s30, s30, 10
  s_and_b32 s33, s29, 7
  s_lshr_b32 s33, s33, 1
  s_lshl_b32 s33, s33, 8
  s_add_u32 s30, s30, s33
  s_and_b32 s33, s29, 1
  s_lshl_b32 s33, s33, 3
  s_add_u32 s30, s30, s33
  s_add_u32 s29, s29, 1
  s_lshr_b32 s31, s29, 3
  s_lshl_b32 s31, s31, 10
  s_and_b32 s33, s29, 7
  s_lshr_b32 s33, s33, 1
  s_lshl_b32 s33, s33, 8
  s_add_u32 s31, s31, s33
  s_and_b32 s33, s29, 1
  s_lshl_b32 s33, s33, 3
  s_add_u32 s31, s31, s33
  v_mov_b32 v217, s30
  v_mov_b32 v218, s31
  v_cndmask_b32 v217, v217, v218, s[16:17]
  v_add_u32 v217, v217, v216
  buffer_store_dwordx2 v[48:49], v217, s[4:7], s34 offen
  s_add_u32 s29, s28, 2
  s_lshr_b32 s30, s29, 3
  s_lshl_b32 s30, s30, 10
  s_and_b32 s33, s29, 7
  s_lshr_b32 s33, s33, 1
  s_lshl_b32 s33, s33, 8
  s_add_u32 s30, s30, s33
  s_and_b32 s33, s29, 1
  s_lshl_b32 s33, s33, 3
  s_add_u32 s30, s30, s33
  s_add_u32 s29, s29, 1
  s_lshr_b32 s31, s29, 3
  s_lshl_b32 s31, s31, 10
  s_and_b32 s33, s29, 7
  s_lshr_b32 s33, s33, 1
  s_lshl_b32 s33, s33, 8
  s_add_u32 s31, s31, s33
  s_and_b32 s33, s29, 1
  s_lshl_b32 s33, s33, 3
  s_add_u32 s31, s31, s33
  v_mov_b32 v217, s30
  v_mov_b32 v218, s31
  v_cndmask_b32 v217, v217, v218, s[16:17]
  v_add_u32 v217, v217, v216
  buffer_store_dwordx2 v[50:51], v217, s[4:7], s34 offen
  s_add_u32 s29, s28, 4
  s_lshr_b32 s30, s29, 3
  s_lshl_b32 s30, s30, 10
  s_and_b32 s33, s29, 7
  s_lshr_b32 s33, s33, 1
  s_lshl_b32 s33, s33, 8
  s_add_u32 s30, s30, s33
  s_and_b32 s33, s29, 1
  s_lshl_b32 s33, s33, 3
  s_add_u32 s30, s30, s33
  s_add_u32 s29, s29, 1
  s_lshr_b32 s31, s29, 3
  s_lshl_b32 s31, s31, 10
  s_and_b32 s33, s29, 7
  s_lshr_b32 s33, s33, 1
  s_lshl_b32 s33, s33, 8
  s_add_u32 s31, s31, s33
  s_and_b32 s33, s29, 1
  s_lshl_b32 s33, s33, 3
  s_add_u32 s31, s31, s33
  v_mov_b32 v217, s30
  v_mov_b32 v218, s31
  v_cndmask_b32 v217, v217, v218, s[16:17]
  v_add_u32 v217, v217, v216
  s_mov_b32 exec_hi, 0
  buffer_store_dwordx2 v[52:53], v217, s[4:7], s34 offen
  s_mov_b32 exec_hi, -1
  s_branch L_att_kernel_end
L_att_kernel_fallback:
  s_nop 4
  s_mov_b32 s25, 1
  v_cndmask_b32 v12, v12, 0, s[16:17]
  v_mov_b32 v216, 0xff800000
  s_mov_b32 s35, s11
  s_mov_b32 s36, 0
L_att_kernel_fb1:
  s_nop 4
  buffer_load_dwordx4 v[88:91], v209, s[4:7], s35 offen
  buffer_load_dwordx2 v[96:97], v210, s[4:7], s35 offen
  s_waitcnt vmcnt(0)
  v_mfma_f32_32x32x16_bf16 v[48:63], v[88:91], v[4:7], 0
  v_mfma_f32_32x32x8bf16_1k v[48:63], v[96:97], v[12:13], v[48:63]
  s_nop 11
  v_max3_f32 v216, v216, v48, v49
  v_max3_f32 v216, v216, v50, v51
  v_max3_f32 v216, v216, v52, v53
  v_max3_f32 v216, v216, v54, v55
  v_max3_f32 v216, v216, v56, v57
  v_max3_f32 v216, v216, v58, v59
  v_max3_f32 v216, v216, v60, v61
  v_max3_f32 v216, v216, v62, v63
  s_add_u32 s35, s35, 3072
  s_add_u32 s36, s36, 1
  s_cmp_lt_u32 s36, 64
  s_cbranch_scc1 L_att_kernel_fb1
  s_nop 4
  v_mov_b32 v223, v216
  s_nop 1
  v_permlane32_swap_b32 v216, v223
  v_max_f32 v216, v216, v223
  v_sub_f32 v216, 0, v216
  v_cvt_pk_bf16_f32 v216, v216, 0
  v_cndmask_b32 v12, v12, v216, s[16:17]
  v_mov_b32 v16, 0
  v_mov_b32 v17, 0
  v_mov_b32 v18, 0
  v_mov_b32 v19, 0
  v_mov_b32 v20, 0
  v_mov_b32 v21, 0
  v_mov_b32 v22, 0
  v_mov_b32 v23, 0
  v_mov_b32 v24, 0
  v_mov_b32 v25, 0
  v_mov_b32 v26, 0
  v_mov_b32 v27, 0
  v_mov_b32 v28, 0
  v_mov_b32 v29, 0
  v_mov_b32 v30, 0
  v_mov_b32 v31, 0
  s_mov_b32 s35, s11
  s_mov_b32 s36, 0
L_att_kernel_fb2:
  s_nop 4
  buffer_load_dwordx4 v[88:91], v209, s[4:7], s35 offen
  buffer_load_dwordx2 v[96:97], v210, s[4:7], s35 offen
  buffer_load_dwordx4 v[100:103], v211, s[4:7], s35 offen
  buffer_load_dwordx4 v[104:107], v211, s[4:7], s35 offen offset:768
  s_waitcnt vmcnt(0)
  v_mfma_f32_32x32x16_bf16 v[48:63], v[88:91], v[4:7], 0
  v_mfma_f32_32x32x8bf16_1k v[48:63], v[96:97], v[12:13], v[48:63]
  s_nop 11
  v_exp_f32 v48, v48
  v_exp_f32 v49, v49
  v_exp_f32 v50, v50
  v_exp_f32 v51, v51
  v_exp_f32 v52, v52
  v_exp_f32 v53, v53
  v_exp_f32 v54, v54
  v_exp_f32 v55, v55
  v_exp_f32 v56, v56
  v_exp_f32 v57, v57
  v_exp_f32 v58, v58
  v_exp_f32 v59, v59
  v_exp_f32 v60, v60
  v_exp_f32 v61, v61
  v_exp_f32 v62, v62
  v_exp_f32 v63, v63
  v_cvt_pk_bf16_f32 v80, v48, v49
  v_cvt_pk_bf16_f32 v81, v50, v51
  v_cvt_pk_bf16_f32 v82, v52, v53
  v_cvt_pk_bf16_f32 v83, v54, v55
  v_cvt_pk_bf16_f32 v84, v56, v57
  v_cvt_pk_bf16_f32 v85, v58, v59
  v_cvt_pk_bf16_f32 v86, v60, v61
  v_cvt_pk_bf16_f32 v87, v62, v63
  v_mfma_f32_32x32x16_bf16 v[16:31], v[100:103], v[80:83], v[16:31]
  s_nop 0
  v_mfma_f32_32x32x16_bf16 v[16:31], v[104:107], v[84:87], v[16:31]
  s_add_u32 s35, s35, 3072
  s_add_u32 s36, s36, 1
  s_cmp_lt_u32 s36, 64
  s_cbranch_scc1 L_att_kernel_fb2
  s_branch L_att_kernel_epi
L_att_kernel_end:
L_att_kernel_exit:
  s_endpgm
.section .rodata,"a"
.p2align 6
.amdhsa_kernel att_kernel
  .amdhsa_next_free_vgpr 256
  .amdhsa_next_free_sgpr 102
  .amdhsa_accum_offset 256
  .amdhsa_group_segment_fixed_size 0
  .amdhsa_kernarg_size 88
  .amdhsa_user_sgpr_count 2
  .amdhsa_user_sgpr_kernarg_segment_ptr 1
  .amdhsa_system_sgpr_workgroup_id_x 1
.end_amdhsa_kernel
.text
.globl out_kernel
.p2align 8
.type out_kernel,@function
out_kernel:
  s_cmp_ge_u32 s2, 256
  s_cbranch_scc1 L_out_kernel_exit
  s_load_dwordx2 s[4:5], s[0:1], 80
  s_load_dwordx2 s[12:13], s[0:1], 64
  v_and_b32 v1, 63, v0
  v_lshrrev_b32 v3, 6, v0
  s_nop 0
  v_readfirstlane_b32 s8, v3
  s_and_b32 s62, s2, 7
  s_lshr_b32 s63, s2, 3
  s_lshl_b32 s9, s62, 2
  s_lshr_b32 s10, s63, 3
  s_add_u32 s9, s9, s10
  s_and_b32 s10, s63, 7
  v_lshlrev_b32 v2, 4, v1
  s_mul_i32 s16, s9, 163840
  s_mul_i32 s17, s8, 10240
  s_add_u32 s16, s16, s17
  s_add_u32 s16, s16, 10485760
  s_mul_i32 s18, s10, 204800
  s_add_u32 s18, s18, s17
  s_add_u32 s18, s18, 29360128
  s_waitcnt lgkmcnt(0)
  s_mov_b32 s6, 0x10000000
  s_mov_b32 s7, 0x00020000
  s_mov_b32 s14, 2621440
  s_mov_b32 s15, 0x00020000
  s_add_u32 s20, s16, 0
  buffer_load_dwordx4 v[96:99], v2, s[4:7], s20 offen
  s_add_u32 s20, s16, 40960
  buffer_load_dwordx4 v[100:103], v2, s[4:7], s20 offen
  s_add_u32 s20, s16, 81920
  buffer_load_dwordx4 v[104:107], v2, s[4:7], s20 offen
  s_add_u32 s20, s16, 122880
  buffer_load_dwordx4 v[108:111], v2, s[4:7], s20 offen
  s_add_u32 s20, s18, 0
  buffer_load_dwordx4 v[112:115], v2, s[4:7], s20 offen
  s_add_u32 s20, s18, 40960
  buffer_load_dwordx4 v[116:119], v2, s[4:7], s20 offen
  s_add_u32 s20, s18, 81920
  buffer_load_dwordx4 v[120:123], v2, s[4:7], s20 offen
  s_add_u32 s20, s18, 122880
  buffer_load_dwordx4 v[124:127], v2, s[4:7], s20 offen
  s_add_u32 s20, s18, 163840
  buffer_load_dwordx4 v[128:131], v2, s[4:7], s20 offen
  s_add_u32 s20, s16, 1024
  buffer_load_dwordx4 v[132:135], v2, s[4:7], s20 offen
  s_add_u32 s20, s16, 41984
  buffer_load_dwordx4 v[136:139], v2, s[4:7], s20 offen
  s_add_u32 s20, s16, 82944
  buffer_load_dwordx4 v[140:143], v2, s[4:7], s20 offen
  s_add_u32 s20, s16, 123904
  buffer_load_dwordx4 v[144:147], v2, s[4:7], s20 offen
  s_add_u32 s20, s18, 1024
  buffer_load_dwordx4 v[148:151], v2, s[4:7], s20 offen
  s_add_u32 s20, s18, 41984
  buffer_load_dwordx4 v[152:155], v2, s[4:7], s20 offen
  s_add_u32 s20, s18, 82944
  buffer_load_dwordx4 v[156:159], v2, s[4:7], s20 offen
  s_add_u32 s20, s18, 123904
  buffer_load_dwordx4 v[160:163], v2, s[4:7], s20 offen
  s_add_u32 s20, s18, 164864
  buffer_load_dwordx4 v[164:167], v2, s[4:7], s20 offen
  s_add_u32 s20, s16, 2048
  buffer_load_dwordx4 v[168:171], v2, s[4:7], s20 offen
  s_add_u32 s20, s16, 43008
  buffer_load_dwordx4 v[172:175], v2, s[4:7], s20 offen
  s_add_u32 s20, s16, 83968
  buffer_load_dwordx4 v[176:179], v2, s[4:7], s20 offen
  s_add_u32 s20, s16, 124928
  buffer_load_dwordx4 v[180:183], v2, s[4:7], s20 offen
  s_add_u32 s20, s18, 2048
  buffer_load_dwordx4 v[184:187], v2, s[4:7], s20 offen
  s_add_u32 s20, s18, 43008
  buffer_load_dwordx4 v[188:191], v2, s[4:7], s20 offen
  s_add_u32 s20, s18, 83968
  buffer_load_dwordx4 v[192:195], v2, s[4:7], s20 offen
  s_add_u32 s20, s18, 124928
  buffer_load_dwordx4 v[196:199], v2, s[4:7], s20 offen
  s_add_u32 s20, s18, 165888
  buffer_load_dwordx4 v[200:203], v2, s[4:7], s20 offen
  s_add_u32 s20, s16, 3072
  buffer_load_dwordx4 v[204:207], v2, s[4:7], s20 offen
  s_add_u32 s20, s16, 44032
  buffer_load_dwordx4 v[208:211], v2, s[4:7], s20 offen
  s_add_u32 s20, s16, 84992
  buffer_load_dwordx4 v[212:215], v2, s[4:7], s20 offen
  s_add_u32 s20, s16, 125952
  buffer_load_dwordx4 v[216:219], v2, s[4:7], s20 offen
  s_add_u32 s20, s18, 3072
  buffer_load_dwordx4 v[220:223], v2, s[4:7], s20 offen
  s_add_u32 s20, s18, 44032
  buffer_load_dwordx4 v[224:227], v2, s[4:7], s20 offen
  s_add_u32 s20, s18, 84992
  buffer_load_dwordx4 v[228:231], v2, s[4:7], s20 offen
  s_add_u32 s20, s18, 125952
  buffer_load_dwordx4 v[232:235], v2, s[4:7], s20 offen
  s_add_u32 s20, s18, 166912
  buffer_load_dwordx4 v[236:239], v2, s[4:7], s20 offen
  s_waitcnt vmcnt(27)
  v_mfma_f32_16x16x32_bf16 v[16:19], v[112:115], v[96:99], 0
  v_mfma_f32_16x16x32_bf16 v[20:23], v[116:119], v[96:99], 0
  v_mfma_f32_16x16x32_bf16 v[24:27], v[120:123], v[96:99], 0
  v_mfma_f32_16x16x32_bf16 v[28:31], v[124:127], v[96:99], 0
  v_mfma_f32_16x16x32_bf16 v[32:35], v[128:131], v[96:99], 0
  v_mfma_f32_16x16x32_bf16 v[36:39], v[112:115], v[100:103], 0
  v_mfma_f32_16x16x32_bf16 v[40:43], v[116:119], v[100:103], 0
  v_mfma_f32_16x16x32_bf16 v[44:47], v[120:123], v[100:103], 0
  v_mfma_f32_16x16x32_bf16 v[48:51], v[124:127], v[100:103], 0
  v_mfma_f32_16x16x32_bf16 v[52:55], v[128:131], v[100:103], 0
  v_mfma_f32_16x16x32_bf16 v[56:59], v[112:115], v[104:107], 0
  v_mfma_f32_16x16x32_bf16 v[60:63], v[116:119], v[104:107], 0
  v_mfma_f32_16x16x32_bf16 v[64:67], v[120:123], v[104:107], 0
  v_mfma_f32_16x16x32_bf16 v[68:71], v[124:127], v[104:107], 0
  v_mfma_f32_16x16x32_bf16 v[72:75], v[128:131], v[104:107], 0
  v_mfma_f32_16x16x32_bf16 v[76:79], v[112:115], v[108:111], 0
  v_mfma_f32_16x16x32_bf16 v[80:83], v[116:119], v[108:111], 0
  v_mfma_f32_16x16x32_bf16 v[84:87], v[120:123], v[108:111], 0
  v_mfma_f32_16x16x32_bf16 v[88:91], v[124:127], v[108:111], 0
  v_mfma_f32_16x16x32_bf16 v[92:95], v[128:131], v[108:111], 0
  s_add_u32 s20, s16, 4096
  buffer_load_dwordx4 v[96:99], v2, s[4:7], s20 offen
  s_add_u32 s20, s16, 45056
  buffer_load_dwordx4 v[100:103], v2, s[4:7], s20 offen
  s_add_u32 s20, s16, 86016
  buffer_load_dwordx4 v[104:107], v2, s[4:7], s20 offen
  s_add_u32 s20, s16, 126976
  buffer_load_dwordx4 v[108:111], v2, s[4:7], s20 offen
  s_add_u32 s20, s18, 4096
  buffer_load_dwordx4 v[112:115], v2, s[4:7], s20 offen
  s_add_u32 s20, s18, 45056
  buffer_load_dwordx4 v[116:119], v2, s[4:7], s20 offen
  s_add_u32 s20, s18, 86016
  buffer_load_dwordx4 v[120:123], v2, s[4:7], s20 offen
  s_add_u32 s20, s18, 126976
  buffer_load_dwordx4 v[124:127], v2, s[4:7], s20 offen
  s_add_u32 s20, s18, 167936
  buffer_load_dwordx4 v[128:131], v2, s[4:7], s20 offen
  s_waitcnt vmcnt(27)
  v_mfma_f32_16x16x32_bf16 v[16:19], v[148:151], v[132:135], v[16:19]
  v_mfma_f32_16x16x32_bf16 v[20:23], v[152:155], v[132:135], v[20:23]
  v_mfma_f32_16x16x32_bf16 v[24:27], v[156:159], v[132:135], v[24:27]
  v_mfma_f32_16x16x32_bf16 v[28:31], v[160:163], v[132:135], v[28:31]
  v_mfma_f32_16x16x32_bf16 v[32:35], v[164:167], v[132:135], v[32:35]
  v_mfma_f32_16x16x32_bf16 v[36:39], v[148:151], v[136:139], v[36:39]
  v_mfma_f32_16x16x32_bf16 v[40:43], v[152:155], v[136:139], v[40:43]
  v_mfma_f32_16x16x32_bf16 v[44:47], v[156:159], v[136:139], v[44:47]
  v_mfma_f32_16x16x32_bf16 v[48:51], v[160:163], v[136:139], v[48:51]
  v_mfma_f32_16x16x32_bf16 v[52:55], v[164:167], v[136:139], v[52:55]
  v_mfma_f32_16x16x32_bf16 v[56:59], v[148:151], v[140:143], v[56:59]
  v_mfma_f32_16x16x32_bf16 v[60:63], v[152:155], v[140:143], v[60:63]
  v_mfma_f32_16x16x32_bf16 v[64:67], v[156:159], v[140:143], v[64:67]
  v_mfma_f32_16x16x32_bf16 v[68:71], v[160:163], v[140:143], v[68:71]
  v_mfma_f32_16x16x32_bf16 v[72:75], v[164:167], v[140:143], v[72:75]
  v_mfma_f32_16x16x32_bf16 v[76:79], v[148:151], v[144:147], v[76:79]
  v_mfma_f32_16x16x32_bf16 v[80:83], v[152:155], v[144:147], v[80:83]
  v_mfma_f32_16x16x32_bf16 v[84:87], v[156:159], v[144:147], v[84:87]
  v_mfma_f32_16x16x32_bf16 v[88:91], v[160:163], v[144:147], v[88:91]
  v_mfma_f32_16x16x32_bf16 v[92:95], v[164:167], v[144:147], v[92:95]
  s_add_u32 s20, s16, 5120
  buffer_load_dwordx4 v[132:135], v2, s[4:7], s20 offen
  s_add_u32 s20, s16, 46080
  buffer_load_dwordx4 v[136:139], v2, s[4:7], s20 offen
  s_add_u32 s20, s16, 87040
  buffer_load_dwordx4 v[140:143], v2, s[4:7], s20 offen
  s_add_u32 s20, s16, 128000
  buffer_load_dwordx4 v[144:147], v2, s[4:7], s20 offen
  s_add_u32 s20, s18, 5120
  buffer_load_dwordx4 v[148:151], v2, s[4:7], s20 offen
  s_add_u32 s20, s18, 46080
  buffer_load_dwordx4 v[152:155], v2, s[4:7], s20 offen
  s_add_u32 s20, s18, 87040
  buffer_load_dwordx4 v[156:159], v2, s[4:7], s20 offen
  s_add_u32 s20, s18, 128000
  buffer_load_dwordx4 v[160:163], v2, s[4:7], s20 offen
  s_add_u32 s20, s18, 168960
  buffer_load_dwordx4 v[164:167], v2, s[4:7], s20 offen
  s_waitcnt vmcnt(27)
  v_mfma_f32_16x16x32_bf16 v[16:19], v[184:187], v[168:171], v[16:19]
  v_mfma_f32_16x16x32_bf16 v[20:23], v[188:191], v[168:171], v[20:23]
  v_mfma_f32_16x16x32_bf16 v[24:27], v[192:195], v[168:171], v[24:27]
  v_mfma_f32_16x16x32_bf16 v[28:31], v[196:199], v[168:171], v[28:31]
  v_mfma_f32_16x16x32_bf16 v[32:35], v[200:203], v[168:171], v[32:35]
  v_mfma_f32_16x16x32_bf16 v[36:39], v[184:187], v[172:175], v[36:39]
  v_mfma_f32_16x16x32_bf16 v[40:43], v[188:191], v[172:175], v[40:43]
  v_mfma_f32_16x16x32_bf16 v[44:47], v[192:195], v[172:175], v[44:47]
  v_mfma_f32_16x16x32_bf16 v[48:51], v[196:199], v[172:175], v[48:51]
  v_mfma_f32_16x16x32_bf16 v[52:55], v[200:203], v[172:175], v[52:55]
  v_mfma_f32_16x16x32_bf16 v[56:59], v[184:187], v[176:179], v[56:59]
  v_mfma_f32_16x16x32_bf16 v[60:63], v[188:191], v[176:179], v[60:63]
  v_mfma_f32_16x16x32_bf16 v[64:67], v[192:195], v[176:179], v[64:67]
  v_mfma_f32_16x16x32_bf16 v[68:71], v[196:199], v[176:179], v[68:71]
  v_mfma_f32_16x16x32_bf16 v[72:75], v[200:203], v[176:179], v[72:75]
  v_mfma_f32_16x16x32_bf16 v[76:79], v[184:187], v[180:183], v[76:79]
  v_mfma_f32_16x16x32_bf16 v[80:83], v[188:191], v[180:183], v[80:83]
  v_mfma_f32_16x16x32_bf16 v[84:87], v[192:195], v[180:183], v[84:87]
  v_mfma_f32_16x16x32_bf16 v[88:91], v[196:199], v[180:183], v[88:91]
  v_mfma_f32_16x16x32_bf16 v[92:95], v[200:203], v[180:183], v[92:95]
  s_add_u32 s20, s16, 6144
  buffer_load_dwordx4 v[168:171], v2, s[4:7], s20 offen
  s_add_u32 s20, s16, 47104
  buffer_load_dwordx4 v[172:175], v2, s[4:7], s20 offen
  s_add_u32 s20, s16, 88064
  buffer_load_dwordx4 v[176:179], v2, s[4:7], s20 offen
  s_add_u32 s20, s16, 129024
  buffer_load_dwordx4 v[180:183], v2, s[4:7], s20 offen
  s_add_u32 s20, s18, 6144
  buffer_load_dwordx4 v[184:187], v2, s[4:7], s20 offen
  s_add_u32 s20, s18, 47104
  buffer_load_dwordx4 v[188:191], v2, s[4:7], s20 offen
  s_add_u32 s20, s18, 88064
  buffer_load_dwordx4 v[192:195], v2, s[4:7], s20 offen
  s_add_u32 s20, s18, 129024
  buffer_load_dwordx4 v[196:199], v2, s[4:7], s20 offen
  s_add_u32 s20, s18, 169984
  buffer_load_dwordx4 v[200:203], v2, s[4:7], s20 offen
  s_waitcnt vmcnt(27)
  v_mfma_f32_16x16x32_bf16 v[16:19], v[220:223], v[204:207], v[16:19]
  v_mfma_f32_16x16x32_bf16 v[20:23], v[224:227], v[204:207], v[20:23]
  v_mfma_f32_16x16x32_bf16 v[24:27], v[228:231], v[204:207], v[24:27]
  v_mfma_f32_16x16x32_bf16 v[28:31], v[232:235], v[204:207], v[28:31]
  v_mfma_f32_16x16x32_bf16 v[32:35], v[236:239], v[204:207], v[32:35]
  v_mfma_f32_16x16x32_bf16 v[36:39], v[220:223], v[208:211], v[36:39]
  v_mfma_f32_16x16x32_bf16 v[40:43], v[224:227], v[208:211], v[40:43]
  v_mfma_f32_16x16x32_bf16 v[44:47], v[228:231], v[208:211], v[44:47]
  v_mfma_f32_16x16x32_bf16 v[48:51], v[232:235], v[208:211], v[48:51]
  v_mfma_f32_16x16x32_bf16 v[52:55], v[236:239], v[208:211], v[52:55]
  v_mfma_f32_16x16x32_bf16 v[56:59], v[220:223], v[212:215], v[56:59]
  v_mfma_f32_16x16x32_bf16 v[60:63], v[224:227], v[212:215], v[60:63]
  v_mfma_f32_16x16x32_bf16 v[64:67], v[228:231], v[212:215], v[64:67]
  v_mfma_f32_16x16x32_bf16 v[68:71], v[232:235], v[212:215], v[68:71]
  v_mfma_f32_16x16x32_bf16 v[72:75], v[236:239], v[212:215], v[72:75]
  v_mfma_f32_16x16x32_bf16 v[76:79], v[220:223], v[216:219], v[76:79]
  v_mfma_f32_16x16x32_bf16 v[80:83], v[224:227], v[216:219], v[80:83]
  v_mfma_f32_16x16x32_bf16 v[84:87], v[228:231], v[216:219], v[84:87]
  v_mfma_f32_16x16x32_bf16 v[88:91], v[232:235], v[216:219], v[88:91]
  v_mfma_f32_16x16x32_bf16 v[92:95], v[236:239], v[216:219], v[92:95]
  s_add_u32 s20, s16, 7168
  buffer_load_dwordx4 v[204:207], v2, s[4:7], s20 offen
  s_add_u32 s20, s16, 48128
  buffer_load_dwordx4 v[208:211], v2, s[4:7], s20 offen
  s_add_u32 s20, s16, 89088
  buffer_load_dwordx4 v[212:215], v2, s[4:7], s20 offen
  s_add_u32 s20, s16, 130048
  buffer_load_dwordx4 v[216:219], v2, s[4:7], s20 offen
  s_add_u32 s20, s18, 7168
  buffer_load_dwordx4 v[220:223], v2, s[4:7], s20 offen
  s_add_u32 s20, s18, 48128
  buffer_load_dwordx4 v[224:227], v2, s[4:7], s20 offen
  s_add_u32 s20, s18, 89088
  buffer_load_dwordx4 v[228:231], v2, s[4:7], s20 offen
  s_add_u32 s20, s18, 130048
  buffer_load_dwordx4 v[232:235], v2, s[4:7], s20 offen
  s_add_u32 s20, s18, 171008
  buffer_load_dwordx4 v[236:239], v2, s[4:7], s20 offen
  s_waitcnt vmcnt(27)
  v_mfma_f32_16x16x32_bf16 v[16:19], v[112:115], v[96:99], v[16:19]
  v_mfma_f32_16x16x32_bf16 v[20:23], v[116:119], v[96:99], v[20:23]
  v_mfma_f32_16x16x32_bf16 v[24:27], v[120:123], v[96:99], v[24:27]
  v_mfma_f32_16x16x32_bf16 v[28:31], v[124:127], v[96:99], v[28:31]
  v_mfma_f32_16x16x32_bf16 v[32:35], v[128:131], v[96:99], v[32:35]
  v_mfma_f32_16x16x32_bf16 v[36:39], v[112:115], v[100:103], v[36:39]
  v_mfma_f32_16x16x32_bf16 v[40:43], v[116:119], v[100:103], v[40:43]
  v_mfma_f32_16x16x32_bf16 v[44:47], v[120:123], v[100:103], v[44:47]
  v_mfma_f32_16x16x32_bf16 v[48:51], v[124:127], v[100:103], v[48:51]
  v_mfma_f32_16x16x32_bf16 v[52:55], v[128:131], v[100:103], v[52:55]
  v_mfma_f32_16x16x32_bf16 v[56:59], v[112:115], v[104:107], v[56:59]
  v_mfma_f32_16x16x32_bf16 v[60:63], v[116:119], v[104:107], v[60:63]
  v_mfma_f32_16x16x32_bf16 v[64:67], v[120:123], v[104:107], v[64:67]
  v_mfma_f32_16x16x32_bf16 v[68:71], v[124:127], v[104:107], v[68:71]
  v_mfma_f32_16x16x32_bf16 v[72:75], v[128:131], v[104:107], v[72:75]
  v_mfma_f32_16x16x32_bf16 v[76:79], v[112:115], v[108:111], v[76:79]
  v_mfma_f32_16x16x32_bf16 v[80:83], v[116:119], v[108:111], v[80:83]
  v_mfma_f32_16x16x32_bf16 v[84:87], v[120:123], v[108:111], v[84:87]
  v_mfma_f32_16x16x32_bf16 v[88:91], v[124:127], v[108:111], v[88:91]
  v_mfma_f32_16x16x32_bf16 v[92:95], v[128:131], v[108:111], v[92:95]
  s_add_u32 s20, s16, 8192
  buffer_load_dwordx4 v[96:99], v2, s[4:7], s20 offen
  s_add_u32 s20, s16, 49152
  buffer_load_dwordx4 v[100:103], v2, s[4:7], s20 offen
  s_add_u32 s20, s16, 90112
  buffer_load_dwordx4 v[104:107], v2, s[4:7], s20 offen
  s_add_u32 s20, s16, 131072
  buffer_load_dwordx4 v[108:111], v2, s[4:7], s20 offen
  s_add_u32 s20, s18, 8192
  buffer_load_dwordx4 v[112:115], v2, s[4:7], s20 offen
  s_add_u32 s20, s18, 49152
  buffer_load_dwordx4 v[116:119], v2, s[4:7], s20 offen
  s_add_u32 s20, s18, 90112
  buffer_load_dwordx4 v[120:123], v2, s[4:7], s20 offen
  s_add_u32 s20, s18, 131072
  buffer_load_dwordx4 v[124:127], v2, s[4:7], s20 offen
  s_add_u32 s20, s18, 172032
  buffer_load_dwordx4 v[128:131], v2, s[4:7], s20 offen
  s_waitcnt vmcnt(27)
  v_mfma_f32_16x16x32_bf16 v[16:19], v[148:151], v[132:135], v[16:19]
  v_mfma_f32_16x16x32_bf16 v[20:23], v[152:155], v[132:135], v[20:23]
  v_mfma_f32_16x16x32_bf16 v[24:27], v[156:159], v[132:135], v[24:27]
  v_mfma_f32_16x16x32_bf16 v[28:31], v[160:163], v[132:135], v[28:31]
  v_mfma_f32_16x16x32_bf16 v[32:35], v[164:167], v[132:135], v[32:35]
  v_mfma_f32_16x16x32_bf16 v[36:39], v[148:151], v[136:139], v[36:39]
  v_mfma_f32_16x16x32_bf16 v[40:43], v[152:155], v[136:139], v[40:43]
  v_mfma_f32_16x16x32_bf16 v[44:47], v[156:159], v[136:139], v[44:47]
  v_mfma_f32_16x16x32_bf16 v[48:51], v[160:163], v[136:139], v[48:51]
  v_mfma_f32_16x16x32_bf16 v[52:55], v[164:167], v[136:139], v[52:55]
  v_mfma_f32_16x16x32_bf16 v[56:59], v[148:151], v[140:143], v[56:59]
  v_mfma_f32_16x16x32_bf16 v[60:63], v[152:155], v[140:143], v[60:63]
  v_mfma_f32_16x16x32_bf16 v[64:67], v[156:159], v[140:143], v[64:67]
  v_mfma_f32_16x16x32_bf16 v[68:71], v[160:163], v[140:143], v[68:71]
  v_mfma_f32_16x16x32_bf16 v[72:75], v[164:167], v[140:143], v[72:75]
  v_mfma_f32_16x16x32_bf16 v[76:79], v[148:151], v[144:147], v[76:79]
  v_mfma_f32_16x16x32_bf16 v[80:83], v[152:155], v[144:147], v[80:83]
  v_mfma_f32_16x16x32_bf16 v[84:87], v[156:159], v[144:147], v[84:87]
  v_mfma_f32_16x16x32_bf16 v[88:91], v[160:163], v[144:147], v[88:91]
  v_mfma_f32_16x16x32_bf16 v[92:95], v[164:167], v[144:147], v[92:95]
  s_add_u32 s20, s16, 9216
  buffer_load_dwordx4 v[132:135], v2, s[4:7], s20 offen
  s_add_u32 s20, s16, 50176
  buffer_load_dwordx4 v[136:139], v2, s[4:7], s20 offen
  s_add_u32 s20, s16, 91136
  buffer_load_dwordx4 v[140:143], v2, s[4:7], s20 offen
  s_add_u32 s20, s16, 132096
  buffer_load_dwordx4 v[144:147], v2, s[4:7], s20 offen
  s_add_u32 s20, s18, 9216
  buffer_load_dwordx4 v[148:151], v2, s[4:7], s20 offen
  s_add_u32 s20, s18, 50176
  buffer_load_dwordx4 v[152:155], v2, s[4:7], s20 offen
  s_add_u32 s20, s18, 91136
  buffer_load_dwordx4 v[156:159], v2, s[4:7], s20 offen
  s_add_u32 s20, s18, 132096
  buffer_load_dwordx4 v[160:163], v2, s[4:7], s20 offen
  s_add_u32 s20, s18, 173056
  buffer_load_dwordx4 v[164:167], v2, s[4:7], s20 offen
  s_waitcnt vmcnt(27)
  v_mfma_f32_16x16x32_bf16 v[16:19], v[184:187], v[168:171], v[16:19]
  v_mfma_f32_16x16x32_bf16 v[20:23], v[188:191], v[168:171], v[20:23]
  v_mfma_f32_16x16x32_bf16 v[24:27], v[192:195], v[168:171], v[24:27]
  v_mfma_f32_16x16x32_bf16 v[28:31], v[196:199], v[168:171], v[28:31]
  v_mfma_f32_16x16x32_bf16 v[32:35], v[200:203], v[168:171], v[32:35]
  v_mfma_f32_16x16x32_bf16 v[36:39], v[184:187], v[172:175], v[36:39]
  v_mfma_f32_16x16x32_bf16 v[40:43], v[188:191], v[172:175], v[40:43]
  v_mfma_f32_16x16x32_bf16 v[44:47], v[192:195], v[172:175], v[44:47]
  v_mfma_f32_16x16x32_bf16 v[48:51], v[196:199], v[172:175], v[48:51]
  v_mfma_f32_16x16x32_bf16 v[52:55], v[200:203], v[172:175], v[52:55]
  v_mfma_f32_16x16x32_bf16 v[56:59], v[184:187], v[176:179], v[56:59]
  v_mfma_f32_16x16x32_bf16 v[60:63], v[188:191], v[176:179], v[60:63]
  v_mfma_f32_16x16x32_bf16 v[64:67], v[192:195], v[176:179], v[64:67]
  v_mfma_f32_16x16x32_bf16 v[68:71], v[196:199], v[176:179], v[68:71]
  v_mfma_f32_16x16x32_bf16 v[72:75], v[200:203], v[176:179], v[72:75]
  v_mfma_f32_16x16x32_bf16 v[76:79], v[184:187], v[180:183], v[76:79]
  v_mfma_f32_16x16x32_bf16 v[80:83], v[188:191], v[180:183], v[80:83]
  v_mfma_f32_16x16x32_bf16 v[84:87], v[192:195], v[180:183], v[84:87]
  v_mfma_f32_16x16x32_bf16 v[88:91], v[196:199], v[180:183], v[88:91]
  v_mfma_f32_16x16x32_bf16 v[92:95], v[200:203], v[180:183], v[92:95]
  s_waitcnt vmcnt(18)
  v_mfma_f32_16x16x32_bf16 v[16:19], v[220:223], v[204:207], v[16:19]
  v_mfma_f32_16x16x32_bf16 v[20:23], v[224:227], v[204:207], v[20:23]
  v_mfma_f32_16x16x32_bf16 v[24:27], v[228:231], v[204:207], v[24:27]
  v_mfma_f32_16x16x32_bf16 v[28:31], v[232:235], v[204:207], v[28:31]
  v_mfma_f32_16x16x32_bf16 v[32:35], v[236:239], v[204:207], v[32:35]
  v_mfma_f32_16x16x32_bf16 v[36:39], v[220:223], v[208:211], v[36:39]
  v_mfma_f32_16x16x32_bf16 v[40:43], v[224:227], v[208:211], v[40:43]
  v_mfma_f32_16x16x32_bf16 v[44:47], v[228:231], v[208:211], v[44:47]
  v_mfma_f32_16x16x32_bf16 v[48:51], v[232:235], v[208:211], v[48:51]
  v_mfma_f32_16x16x32_bf16 v[52:55], v[236:239], v[208:211], v[52:55]
  v_mfma_f32_16x16x32_bf16 v[56:59], v[220:223], v[212:215], v[56:59]
  v_mfma_f32_16x16x32_bf16 v[60:63], v[224:227], v[212:215], v[60:63]
  v_mfma_f32_16x16x32_bf16 v[64:67], v[228:231], v[212:215], v[64:67]
  v_mfma_f32_16x16x32_bf16 v[68:71], v[232:235], v[212:215], v[68:71]
  v_mfma_f32_16x16x32_bf16 v[72:75], v[236:239], v[212:215], v[72:75]
  v_mfma_f32_16x16x32_bf16 v[76:79], v[220:223], v[216:219], v[76:79]
  v_mfma_f32_16x16x32_bf16 v[80:83], v[224:227], v[216:219], v[80:83]
  v_mfma_f32_16x16x32_bf16 v[84:87], v[228:231], v[216:219], v[84:87]
  v_mfma_f32_16x16x32_bf16 v[88:91], v[232:235], v[216:219], v[88:91]
  v_mfma_f32_16x16x32_bf16 v[92:95], v[236:239], v[216:219], v[92:95]
  s_waitcnt vmcnt(9)
  v_mfma_f32_16x16x32_bf16 v[16:19], v[112:115], v[96:99], v[16:19]
  v_mfma_f32_16x16x32_bf16 v[20:23], v[116:119], v[96:99], v[20:23]
  v_mfma_f32_16x16x32_bf16 v[24:27], v[120:123], v[96:99], v[24:27]
  v_mfma_f32_16x16x32_bf16 v[28:31], v[124:127], v[96:99], v[28:31]
  v_mfma_f32_16x16x32_bf16 v[32:35], v[128:131], v[96:99], v[32:35]
  v_mfma_f32_16x16x32_bf16 v[36:39], v[112:115], v[100:103], v[36:39]
  v_mfma_f32_16x16x32_bf16 v[40:43], v[116:119], v[100:103], v[40:43]
  v_mfma_f32_16x16x32_bf16 v[44:47], v[120:123], v[100:103], v[44:47]
  v_mfma_f32_16x16x32_bf16 v[48:51], v[124:127], v[100:103], v[48:51]
  v_mfma_f32_16x16x32_bf16 v[52:55], v[128:131], v[100:103], v[52:55]
  v_mfma_f32_16x16x32_bf16 v[56:59], v[112:115], v[104:107], v[56:59]
  v_mfma_f32_16x16x32_bf16 v[60:63], v[116:119], v[104:107], v[60:63]
  v_mfma_f32_16x16x32_bf16 v[64:67], v[120:123], v[104:107], v[64:67]
  v_mfma_f32_16x16x32_bf16 v[68:71], v[124:127], v[104:107], v[68:71]
  v_mfma_f32_16x16x32_bf16 v[72:75], v[128:131], v[104:107], v[72:75]
  v_mfma_f32_16x16x32_bf16 v[76:79], v[112:115], v[108:111], v[76:79]
  v_mfma_f32_16x16x32_bf16 v[80:83], v[116:119], v[108:111], v[80:83]
  v_mfma_f32_16x16x32_bf16 v[84:87], v[120:123], v[108:111], v[84:87]
  v_mfma_f32_16x16x32_bf16 v[88:91], v[124:127], v[108:111], v[88:91]
  v_mfma_f32_16x16x32_bf16 v[92:95], v[128:131], v[108:111], v[92:95]
  s_waitcnt vmcnt(0)
  v_mfma_f32_16x16x32_bf16 v[16:19], v[148:151], v[132:135], v[16:19]
  v_mfma_f32_16x16x32_bf16 v[20:23], v[152:155], v[132:135], v[20:23]
  v_mfma_f32_16x16x32_bf16 v[24:27], v[156:159], v[132:135], v[24:27]
  v_mfma_f32_16x16x32_bf16 v[28:31], v[160:163], v[132:135], v[28:31]
  v_mfma_f32_16x16x32_bf16 v[32:35], v[164:167], v[132:135], v[32:35]
  v_mfma_f32_16x16x32_bf16 v[36:39], v[148:151], v[136:139], v[36:39]
  v_mfma_f32_16x16x32_bf16 v[40:43], v[152:155], v[136:139], v[40:43]
  v_mfma_f32_16x16x32_bf16 v[44:47], v[156:159], v[136:139], v[44:47]
  v_mfma_f32_16x16x32_bf16 v[48:51], v[160:163], v[136:139], v[48:51]
  v_mfma_f32_16x16x32_bf16 v[52:55], v[164:167], v[136:139], v[52:55]
  v_mfma_f32_16x16x32_bf16 v[56:59], v[148:151], v[140:143], v[56:59]
  v_mfma_f32_16x16x32_bf16 v[60:63], v[152:155], v[140:143], v[60:63]
  v_mfma_f32_16x16x32_bf16 v[64:67], v[156:159], v[140:143], v[64:67]
  v_mfma_f32_16x16x32_bf16 v[68:71], v[160:163], v[140:143], v[68:71]
  v_mfma_f32_16x16x32_bf16 v[72:75], v[164:167], v[140:143], v[72:75]
  v_mfma_f32_16x16x32_bf16 v[76:79], v[148:151], v[144:147], v[76:79]
  v_mfma_f32_16x16x32_bf16 v[80:83], v[152:155], v[144:147], v[80:83]
  v_mfma_f32_16x16x32_bf16 v[84:87], v[156:159], v[144:147], v[84:87]
  v_mfma_f32_16x16x32_bf16 v[88:91], v[160:163], v[144:147], v[88:91]
  v_mfma_f32_16x16x32_bf16 v[92:95], v[164:167], v[144:147], v[92:95]
  s_nop 7
  s_cmp_eq_u32 s8, 0
  s_cbranch_scc1 L_out_kernel_skipw0
  s_cmp_gt_u32 s8, 0
  s_cselect_b32 s22, 1, 0
  s_sub_u32 s22, s8, s22
  s_lshl_b32 s22, s22, 10
  v_add_u32 v4, s22, v2
  ds_write_b128 v4, v[16:19] offset:0
L_out_kernel_skipw0:
  s_cmp_eq_u32 s8, 1
  s_cbranch_scc1 L_out_kernel_skipw1
  s_cmp_gt_u32 s8, 1
  s_cselect_b32 s22, 1, 0
  s_sub_u32 s22, s8, s22
  s_lshl_b32 s22, s22, 10
  v_add_u32 v4, s22, v2
  ds_write_b128 v4, v[20:23] offset:3072
L_out_kernel_skipw1:
  s_cmp_eq_u32 s8, 2
  s_cbranch_scc1 L_out_kernel_skipw2
  s_cmp_gt_u32 s8, 2
  s_cselect_b32 s22, 1, 0
  s_sub_u32 s22, s8, s22
  s_lshl_b32 s22, s22, 10
  v_add_u32 v4, s22, v2
  ds_write_b128 v4, v[24:27] offset:6144
L_out_kernel_skipw2:
  s_cmp_eq_u32 s8, 3
  s_cbranch_scc1 L_out_kernel_skipw3
  s_cmp_gt_u32 s8, 3
  s_cselect_b32 s22, 1, 0
  s_sub_u32 s22, s8, s22
  s_lshl_b32 s22, s22, 10
  v_add_u32 v4, s22, v2
  ds_write_b128 v4, v[28:31] offset:9216
L_out_kernel_skipw3:
  s_cmp_eq_u32 s8, 0
  s_cbranch_scc1 L_out_kernel_skipw4
  s_cmp_gt_u32 s8, 0
  s_cselect_b32 s22, 1, 0
  s_sub_u32 s22, s8, s22
  s_lshl_b32 s22, s22, 10
  v_add_u32 v4, s22, v2
  ds_write_b128 v4, v[32:35] offset:12288
L_out_kernel_skipw4:
  s_cmp_eq_u32 s8, 1
  s_cbranch_scc1 L_out_kernel_skipw5
  s_cmp_gt_u32 s8, 1
  s_cselect_b32 s22, 1, 0
  s_sub_u32 s22, s8, s22
  s_lshl_b32 s22, s22, 10
  v_add_u32 v4, s22, v2
  ds_write_b128 v4, v[36:39] offset:15360
L_out_kernel_skipw5:
  s_cmp_eq_u32 s8, 2
  s_cbranch_scc1 L_out_kernel_skipw6
  s_cmp_gt_u32 s8, 2
  s_cselect_b32 s22, 1, 0
  s_sub_u32 s22, s8, s22
  s_lshl_b32 s22, s22, 10
  v_add_u32 v4, s22, v2
  ds_write_b128 v4, v[40:43] offset:18432
L_out_kernel_skipw6:
  s_cmp_eq_u32 s8, 3
  s_cbranch_scc1 L_out_kernel_skipw7
  s_cmp_gt_u32 s8, 3
  s_cselect_b32 s22, 1, 0
  s_sub_u32 s22, s8, s22
  s_lshl_b32 s22, s22, 10
  v_add_u32 v4, s22, v2
  ds_write_b128 v4, v[44:47] offset:21504
L_out_kernel_skipw7:
  s_cmp_eq_u32 s8, 0
  s_cbranch_scc1 L_out_kernel_skipw8
  s_cmp_gt_u32 s8, 0
  s_cselect_b32 s22, 1, 0
  s_sub_u32 s22, s8, s22
  s_lshl_b32 s22, s22, 10
  v_add_u32 v4, s22, v2
  ds_write_b128 v4, v[48:51] offset:24576
L_out_kernel_skipw8:
  s_cmp_eq_u32 s8, 1
  s_cbranch_scc1 L_out_kernel_skipw9
  s_cmp_gt_u32 s8, 1
  s_cselect_b32 s22, 1, 0
  s_sub_u32 s22, s8, s22
  s_lshl_b32 s22, s22, 10
  v_add_u32 v4, s22, v2
  ds_write_b128 v4, v[52:55] offset:27648
L_out_kernel_skipw9:
  s_cmp_eq_u32 s8, 2
  s_cbranch_scc1 L_out_kernel_skipw10
  s_cmp_gt_u32 s8, 2
  s_cselect_b32 s22, 1, 0
  s_sub_u32 s22, s8, s22
  s_lshl_b32 s22, s22, 10
  v_add_u32 v4, s22, v2
  ds_write_b128 v4, v[56:59] offset:30720
L_out_kernel_skipw10:
  s_cmp_eq_u32 s8, 3
  s_cbranch_scc1 L_out_kernel_skipw11
  s_cmp_gt_u32 s8, 3
  s_cselect_b32 s22, 1, 0
  s_sub_u32 s22, s8, s22
  s_lshl_b32 s22, s22, 10
  v_add_u32 v4, s22, v2
  ds_write_b128 v4, v[60:63] offset:33792
L_out_kernel_skipw11:
  s_cmp_eq_u32 s8, 0
  s_cbranch_scc1 L_out_kernel_skipw12
  s_cmp_gt_u32 s8, 0
  s_cselect_b32 s22, 1, 0
  s_sub_u32 s22, s8, s22
  s_lshl_b32 s22, s22, 10
  v_add_u32 v4, s22, v2
  ds_write_b128 v4, v[64:67] offset:36864
L_out_kernel_skipw12:
  s_cmp_eq_u32 s8, 1
  s_cbranch_scc1 L_out_kernel_skipw13
  s_cmp_gt_u32 s8, 1
  s_cselect_b32 s22, 1, 0
  s_sub_u32 s22, s8, s22
  s_lshl_b32 s22, s22, 10
  v_add_u32 v4, s22, v2
  ds_write_b128 v4, v[68:71] offset:39936
L_out_kernel_skipw13:
  s_cmp_eq_u32 s8, 2
  s_cbranch_scc1 L_out_kernel_skipw14
  s_cmp_gt_u32 s8, 2
  s_cselect_b32 s22, 1, 0
  s_sub_u32 s22, s8, s22
  s_lshl_b32 s22, s22, 10
  v_add_u32 v4, s22, v2
  ds_write_b128 v4, v[72:75] offset:43008
L_out_kernel_skipw14:
  s_cmp_eq_u32 s8, 3
  s_cbranch_scc1 L_out_kernel_skipw15
  s_cmp_gt_u32 s8, 3
  s_cselect_b32 s22, 1, 0
  s_sub_u32 s22, s8, s22
  s_lshl_b32 s22, s22, 10
  v_add_u32 v4, s22, v2
  ds_write_b128 v4, v[76:79] offset:46080
L_out_kernel_skipw15:
  s_cmp_eq_u32 s8, 0
  s_cbranch_scc1 L_out_kernel_skipw16
  s_cmp_gt_u32 s8, 0
  s_cselect_b32 s22, 1, 0
  s_sub_u32 s22, s8, s22
  s_lshl_b32 s22, s22, 10
  v_add_u32 v4, s22, v2
  ds_write_b128 v4, v[80:83] offset:49152
L_out_kernel_skipw16:
  s_cmp_eq_u32 s8, 1
  s_cbranch_scc1 L_out_kernel_skipw17
  s_cmp_gt_u32 s8, 1
  s_cselect_b32 s22, 1, 0
  s_sub_u32 s22, s8, s22
  s_lshl_b32 s22, s22, 10
  v_add_u32 v4, s22, v2
  ds_write_b128 v4, v[84:87] offset:52224
L_out_kernel_skipw17:
  s_cmp_eq_u32 s8, 2
  s_cbranch_scc1 L_out_kernel_skipw18
  s_cmp_gt_u32 s8, 2
  s_cselect_b32 s22, 1, 0
  s_sub_u32 s22, s8, s22
  s_lshl_b32 s22, s22, 10
  v_add_u32 v4, s22, v2
  ds_write_b128 v4, v[88:91] offset:55296
L_out_kernel_skipw18:
  s_cmp_eq_u32 s8, 3
  s_cbranch_scc1 L_out_kernel_skipw19
  s_cmp_gt_u32 s8, 3
  s_cselect_b32 s22, 1, 0
  s_sub_u32 s22, s8, s22
  s_lshl_b32 s22, s22, 10
  v_add_u32 v4, s22, v2
  ds_write_b128 v4, v[92:95] offset:58368
L_out_kernel_skipw19:
  s_waitcnt lgkmcnt(0)
  s_barrier
  s_mul_i32 s22, s8, 3072
  v_add_u32 v4, s22, v2
  v_and_b32 v5, 15, v1
  v_mul_u32_u24 v5, 1280, v5
  v_lshrrev_b32 v6, 4, v1
  v_lshl_add_u32 v5, v6, 3, v5
  ds_read_b128 v[96:99], v4 offset:0
  ds_read_b128 v[100:103], v4 offset:1024
  ds_read_b128 v[104:107], v4 offset:2048
  ds_read_b128 v[108:111], v4 offset:12288
  ds_read_b128 v[112:115], v4 offset:13312
  ds_read_b128 v[116:119], v4 offset:14336
  ds_read_b128 v[120:123], v4 offset:24576
  ds_read_b128 v[124:127], v4 offset:25600
  ds_read_b128 v[128:131], v4 offset:26624
  ds_read_b128 v[132:135], v4 offset:36864
  ds_read_b128 v[136:139], v4 offset:37888
  ds_read_b128 v[140:143], v4 offset:38912
  ds_read_b128 v[144:147], v4 offset:49152
  ds_read_b128 v[148:151], v4 offset:50176
  ds_read_b128 v[152:155], v4 offset:51200
  s_cmp_lg_u32 s8, 0
  s_cbranch_scc1 L_out_kernel_sel0
  v_mov_b32 v160, v16
  v_mov_b32 v161, v17
  v_mov_b32 v162, v18
  v_mov_b32 v163, v19
  v_mov_b32 v164, v32
  v_mov_b32 v165, v33
  v_mov_b32 v166, v34
  v_mov_b32 v167, v35
  v_mov_b32 v168, v48
  v_mov_b32 v169, v49
  v_mov_b32 v170, v50
  v_mov_b32 v171, v51
  v_mov_b32 v172, v64
  v_mov_b32 v173, v65
  v_mov_b32 v174, v66
  v_mov_b32 v175, v67
  v_mov_b32 v176, v80
  v_mov_b32 v177, v81
  v_mov_b32 v178, v82
  v_mov_b32 v179, v83
L_out_kernel_sel0:
  s_cmp_lg_u32 s8, 1
  s_cbranch_scc1 L_out_kernel_sel1
  v_mov_b32 v160, v20
  v_mov_b32 v161, v21
  v_mov_b32 v162, v22
  v_mov_b32 v163, v23
  v_mov_b32 v164, v36
  v_mov_b32 v165, v37
  v_mov_b32 v166, v38
  v_mov_b32 v167, v39
  v_mov_b32 v168, v52
  v_mov_b32 v169, v53
  v_mov_b32 v170, v54
  v_mov_b32 v171, v55
  v_mov_b32 v172, v68
  v_mov_b32 v173, v69
  v_mov_b32 v174, v70
  v_mov_b32 v175, v71
  v_mov_b32 v176, v84
  v_mov_b32 v177, v85
  v_mov_b32 v178, v86
  v_mov_b32 v179, v87
L_out_kernel_sel1:
  s_cmp_lg_u32 s8, 2
  s_cbranch_scc1 L_out_kernel_sel2
  v_mov_b32 v160, v24
  v_mov_b32 v161, v25
  v_mov_b32 v162, v26
  v_mov_b32 v163, v27
  v_mov_b32 v164, v40
  v_mov_b32 v165, v41
  v_mov_b32 v166, v42
  v_mov_b32 v167, v43
  v_mov_b32 v168, v56
  v_mov_b32 v169, v57
  v_mov_b32 v170, v58
  v_mov_b32 v171, v59
  v_mov_b32 v172, v72
  v_mov_b32 v173, v73
  v_mov_b32 v174, v74
  v_mov_b32 v175, v75
  v_mov_b32 v176, v88
  v_mov_b32 v177, v89
  v_mov_b32 v178, v90
  v_mov_b32 v179, v91
L_out_kernel_sel2:
  s_cmp_lg_u32 s8, 3
  s_cbranch_scc1 L_out_kernel_sel3
  v_mov_b32 v160, v28
  v_mov_b32 v161, v29
  v_mov_b32 v162, v30
  v_mov_b32 v163, v31
  v_mov_b32 v164, v44
  v_mov_b32 v165, v45
  v_mov_b32 v166, v46
  v_mov_b32 v167, v47
  v_mov_b32 v168, v60
  v_mov_b32 v169, v61
  v_mov_b32 v170, v62
  v_mov_b32 v171, v63
  v_mov_b32 v172, v76
  v_mov_b32 v173, v77
  v_mov_b32 v174, v78
  v_mov_b32 v175, v79
  v_mov_b32 v176, v92
  v_mov_b32 v177, v93
  v_mov_b32 v178, v94
  v_mov_b32 v179, v95
L_out_kernel_sel3:
  s_waitcnt lgkmcnt(0)
  v_add_f32 v160, v160, v96
  v_add_f32 v161, v161, v97
  v_add_f32 v162, v162, v98
  v_add_f32 v163, v163, v99
  v_add_f32 v160, v160, v100
  v_add_f32 v161, v161, v101
  v_add_f32 v162, v162, v102
  v_add_f32 v163, v163, v103
  v_add_f32 v160, v160, v104
  v_add_f32 v161, v161, v105
  v_add_f32 v162, v162, v106
  v_add_f32 v163, v163, v107
  v_cvt_pk_bf16_f32 v184, v160, v161
  v_cvt_pk_bf16_f32 v185, v162, v163
  s_add_u32 s23, s8, 0
  s_mul_i32 s24, s23, 52
  s_lshr_b32 s24, s24, 8
  s_mul_i32 s25, s24, 5
  s_sub_u32 s25, s23, s25
  s_lshl_b32 s26, s9, 6
  s_lshl_b32 s24, s24, 4
  s_add_u32 s26, s26, s24
  s_mul_i32 s26, s26, 1280
  s_mul_i32 s27, s10, 160
  s_lshl_b32 s25, s25, 5
  s_add_u32 s26, s26, s27
  s_add_u32 s26, s26, s25
  buffer_store_dwordx2 v[184:185], v5, s[12:15], s26 offen
  v_add_f32 v164, v164, v108
  v_add_f32 v165, v165, v109
  v_add_f32 v166, v166, v110
  v_add_f32 v167, v167, v111
  v_add_f32 v164, v164, v112
  v_add_f32 v165, v165, v113
  v_add_f32 v166, v166, v114
  v_add_f32 v167, v167, v115
  v_add_f32 v164, v164, v116
  v_add_f32 v165, v165, v117
  v_add_f32 v166, v166, v118
  v_add_f32 v167, v167, v119
  v_cvt_pk_bf16_f32 v186, v164, v165
  v_cvt_pk_bf16_f32 v187, v166, v167
  s_add_u32 s23, s8, 4
  s_mul_i32 s24, s23, 52
  s_lshr_b32 s24, s24, 8
  s_mul_i32 s25, s24, 5
  s_sub_u32 s25, s23, s25
  s_lshl_b32 s26, s9, 6
  s_lshl_b32 s24, s24, 4
  s_add_u32 s26, s26, s24
  s_mul_i32 s26, s26, 1280
  s_mul_i32 s27, s10, 160
  s_lshl_b32 s25, s25, 5
  s_add_u32 s26, s26, s27
  s_add_u32 s26, s26, s25
  buffer_store_dwordx2 v[186:187], v5, s[12:15], s26 offen
  v_add_f32 v168, v168, v120
  v_add_f32 v169, v169, v121
  v_add_f32 v170, v170, v122
  v_add_f32 v171, v171, v123
  v_add_f32 v168, v168, v124
  v_add_f32 v169, v169, v125
  v_add_f32 v170, v170, v126
  v_add_f32 v171, v171, v127
  v_add_f32 v168, v168, v128
  v_add_f32 v169, v169, v129
  v_add_f32 v170, v170, v130
  v_add_f32 v171, v171, v131
  v_cvt_pk_bf16_f32 v188, v168, v169
  v_cvt_pk_bf16_f32 v189, v170, v171
  s_add_u32 s23, s8, 8
  s_mul_i32 s24, s23, 52
  s_lshr_b32 s24, s24, 8
  s_mul_i32 s25, s24, 5
  s_sub_u32 s25, s23, s25
  s_lshl_b32 s26, s9, 6
  s_lshl_b32 s24, s24, 4
  s_add_u32 s26, s26, s24
  s_mul_i32 s26, s26, 1280
  s_mul_i32 s27, s10, 160
  s_lshl_b32 s25, s25, 5
  s_add_u32 s26, s26, s27
  s_add_u32 s26, s26, s25
  buffer_store_dwordx2 v[188:189], v5, s[12:15], s26 offen
  v_add_f32 v172, v172, v132
  v_add_f32 v173, v173, v133
  v_add_f32 v174, v174, v134
  v_add_f32 v175, v175, v135
  v_add_f32 v172, v172, v136
  v_add_f32 v173, v173, v137
  v_add_f32 v174, v174, v138
  v_add_f32 v175, v175, v139
  v_add_f32 v172, v172, v140
  v_add_f32 v173, v173, v141
  v_add_f32 v174, v174, v142
  v_add_f32 v175, v175, v143
  v_cvt_pk_bf16_f32 v190, v172, v173
  v_cvt_pk_bf16_f32 v191, v174, v175
  s_add_u32 s23, s8, 12
  s_mul_i32 s24, s23, 52
  s_lshr_b32 s24, s24, 8
  s_mul_i32 s25, s24, 5
  s_sub_u32 s25, s23, s25
  s_lshl_b32 s26, s9, 6
  s_lshl_b32 s24, s24, 4
  s_add_u32 s26, s26, s24
  s_mul_i32 s26, s26, 1280
  s_mul_i32 s27, s10, 160
  s_lshl_b32 s25, s25, 5
  s_add_u32 s26, s26, s27
  s_add_u32 s26, s26, s25
  buffer_store_dwordx2 v[190:191], v5, s[12:15], s26 offen
  v_add_f32 v176, v176, v144
  v_add_f32 v177, v177, v145
  v_add_f32 v178, v178, v146
  v_add_f32 v179, v179, v147
  v_add_f32 v176, v176, v148
  v_add_f32 v177, v177, v149
  v_add_f32 v178, v178, v150
  v_add_f32 v179, v179, v151
  v_add_f32 v176, v176, v152
  v_add_f32 v177, v177, v153
  v_add_f32 v178, v178, v154
  v_add_f32 v179, v179, v155
  v_cvt_pk_bf16_f32 v192, v176, v177
  v_cvt_pk_bf16_f32 v193, v178, v179
  s_add_u32 s23, s8, 16
  s_mul_i32 s24, s23, 52
  s_lshr_b32 s24, s24, 8
  s_mul_i32 s25, s24, 5
  s_sub_u32 s25, s23, s25
  s_lshl_b32 s26, s9, 6
  s_lshl_b32 s24, s24, 4
  s_add_u32 s26, s26, s24
  s_mul_i32 s26, s26, 1280
  s_mul_i32 s27, s10, 160
  s_lshl_b32 s25, s25, 5
  s_add_u32 s26, s26, s27
  s_add_u32 s26, s26, s25
  buffer_store_dwordx2 v[192:193], v5, s[12:15], s26 offen
L_out_kernel_end:
L_out_kernel_exit:
  s_endpgm
.section .rodata,"a"
.p2align 6
.amdhsa_kernel out_kernel
  .amdhsa_next_free_vgpr 240
  .amdhsa_next_free_sgpr 100
  .amdhsa_accum_offset 240
  .amdhsa_group_segment_fixed_size 0
  .amdhsa_kernarg_size 88
  .amdhsa_user_sgpr_count 2
  .amdhsa_user_sgpr_kernarg_segment_ptr 1
  .amdhsa_system_sgpr_workgroup_id_x 1
.end_amdhsa_kernel
.text
```
